```python
import torch

def _softmax(x, axis=-1):
    return torch.softmax(x, dim=axis)

def _gelu(x):
    return torch.nn.functional.gelu(x, approximate='tanh')

def _silu(x):
    return torch.nn.functional.silu(x)

def _sigmoid(x):
    return torch.sigmoid(x)

def _layernorm(x, axis=-1, eps=1e-05):
    m = x.mean(dim=axis, keepdim=True)
    v = x.var(dim=axis, keepdim=True, unbiased=False)
    return (x - m) / torch.sqrt(v + eps)

def _scatter_add(tgt, idx, src, axis=0):
    return tgt.clone().index_add_(axis, idx, src)

def _segment_sum(src, seg, n):
    out = torch.zeros((n,) + src.shape[1:], dtype=src.dtype)
    return out.index_add_(0, seg, src)

def _pad(x, pw):
    flat = tuple((v for pair in reversed(pw) for v in pair))
    return torch.nn.functional.pad(x, flat)
kernel_name = 'gated_mix__spectral_fnet__mixer_gmlp__prompt'

def setup_inputs():

    _w = lambda a: (lambda t: t.to(torch.bfloat16) if t.is_floating_point() else t)(torch.as_tensor(a))

    def _A_setup():
        B, S, D = (1, 2048, 448)
        ns = torch.arange(S)[:, None] * torch.arange(S)[None, :]
        nd = torch.arange(D)[:, None] * torch.arange(D)[None, :]
        Ws_re = torch.cos(-2.0 * torch.pi * ns / S).to(float)
        Ws_im = torch.sin(-2.0 * torch.pi * ns / S).to(float)
        Wd_re = torch.cos(-2.0 * torch.pi * nd / D).to(float)
        Wd_im = torch.sin(-2.0 * torch.pi * nd / D).to(float)
        return {'x': _w((lambda *s: torch.randn(*s, dtype=torch.bfloat16) * 0.05)(B, S, D)), 'dft_seq_re': _w(Ws_re), 'dft_seq_im': _w(Ws_im), 'dft_hid_re': _w(Wd_re), 'dft_hid_im': _w(Wd_im)}
    _A_in = _A_setup()

    def _B_setup():
        B, S, D, F = (1, 2048, 448, 1792)
        Fh = F // 2
        return {'x': _w((lambda *s: torch.randn(*s, dtype=torch.bfloat16) * 0.05)(B, S, D)), 'w_in': _w((lambda *s: torch.randn(*s, dtype=torch.bfloat16) * 0.8)(D, 2 * Fh)), 'w_sp': _w(0.01 * (lambda *s: torch.randn(*s, dtype=torch.bfloat16) * 0.8)(S, S)), 'b_sp': _w(1.0 + 0.01 * (lambda *s: torch.randn(*s, dtype=torch.bfloat16) * 0.8)(S)), 'w_out': _w((lambda *s: torch.randn(*s, dtype=torch.bfloat16) * 0.8)(Fh, D))}
    _B_in = _B_setup()
    return {'A_x': _A_in['x'], 'A_dft_seq_re': _A_in['dft_seq_re'], 'A_dft_seq_im': _A_in['dft_seq_im'], 'A_dft_hid_re': _A_in['dft_hid_re'], 'A_dft_hid_im': _A_in['dft_hid_im'], 'B_x': _B_in['x'], 'B_w_in': _B_in['w_in'], 'B_w_sp': _B_in['w_sp'], 'B_b_sp': _B_in['b_sp'], 'B_w_out': _B_in['w_out'], 'gate_w': _w((lambda *s: torch.randn(*s, dtype=torch.bfloat16) * 0.05)(448) * 16.0)}

def reference(A_x, A_dft_seq_re, A_dft_seq_im, A_dft_hid_re, A_dft_hid_im, B_x, B_w_in, B_w_sp, B_b_sp, B_w_out, gate_w):

    def _A_ref(x, dft_seq_re, dft_seq_im, dft_hid_re, dft_hid_im):
        a = torch.einsum('bsd,ed->bse', x, dft_hid_re)
        b = torch.einsum('bsd,ed->bse', x, dft_hid_im)
        y = torch.einsum('ts,bse->bte', dft_seq_re, a) - torch.einsum('ts,bse->bte', dft_seq_im, b)
        return y

    def _B_ref(x, w_in, w_sp, b_sp, w_out):
        B, S, D = x.shape
        F = w_in.shape[-1]
        Fh = F // 2
        z = _gelu(torch.einsum('bsd,df->bsf', x, w_in))
        z1 = z[..., :Fh].clone()
        z2 = _layernorm(z[..., Fh:], axis=-1)
        g = torch.einsum('ts,bsf->btf', w_sp, z2) + b_sp[None, :, None]
        return torch.einsum('bsf,fd->bsd', z1 * g, w_out)
    x = A_x
    g = _sigmoid((x * gate_w).sum(-1, keepdims=True))
    a = _A_ref(x, A_dft_seq_re, A_dft_seq_im, A_dft_hid_re, A_dft_hid_im)
    b = _B_ref(x, B_w_in, B_w_sp, B_b_sp, B_w_out)
    return g * a + (1 - g) * b
```

```asm
; @launch kernel=k1_kernel grid=(256,1,1) block=(512,1,1) lds=163840
.amdgcn_target "amdgcn-amd-amdhsa--gfx950"
.text
.globl k1_kernel
.p2align 8
.type k1_kernel,@function
k1_kernel:
    s_cmp_ge_u32 s2, 256
    s_cbranch_scc1 L_k1end_1

    s_load_dwordx2 s[4:5], s[0:1], 0
    s_load_dwordx4 s[8:11], s[0:1], 24
    s_load_dwordx2 s[12:13], s[0:1], 48
    s_load_dwordx4 s[16:19], s[0:1], 72
    s_load_dwordx4 s[20:23], s[0:1], 96
    s_and_b32 s52, s2, 7
    s_lshr_b32 s53, s2, 3
    v_lshrrev_b32 v1, 6, v0
    v_and_b32 v0, 63, v0
    v_readfirstlane_b32 s54, v1
    s_cmp_ge_u32 s53, 28

    s_cbranch_scc0 L_k1gemm
    s_getpc_b64 s[60:61]
    L_cpf:
    s_sub_u32 s60, s60, L_cpf-k1_kernel
    s_subb_u32 s61, s61, 0
    s_lshl_b32 s55, s54, 13
    v_lshlrev_b32 v1, 7, v0
    v_add_u32 v1, s55, v1
    v_min_u32 v1, L_code_end-k1_kernel-4, v1
    global_load_dword v120, v1, s[60:61]
    s_branch L_k1help_2
    L_k1gemm:

    s_mul_i32 s55, s53, 37
    s_lshr_b32 s55, s55, 8
    s_mul_i32 s56, s55, 7
    s_sub_u32 s56, s53, s56
    s_lshr_b32 s57, s52, 1
    s_lshl_b32 s57, s57, 2
    s_add_u32 s57, s57, s55
    s_and_b32 s59, s52, 1
    s_mul_i32 s58, s59, 7
    s_add_u32 s58, s58, s56

    v_lshrrev_b32 v208, 3, v0
    v_lshrrev_b32 v209, 2, v208
    v_lshlrev_b32 v209, 3, v209
    v_and_b32 v210, 3, v208
    v_add_u32 v209, v209, v210
    v_and_b32 v210, 7, v0
    v_lshrrev_b32 v211, 1, v208
    v_xor_b32 v212, v210, v211
    v_lshlrev_b32 v212, 4, v212
    s_lshr_b32 s60, s54, 1
    s_and_b32 s61, s54, 1
    s_lshl_b32 s62, s60, 5
    s_lshl_b32 s63, s61, 2
    s_add_u32 s62, s62, s63
    v_add_u32 v213, s62, v209
    v_mul_u32_u24 v213, 896, v213
    v_add_u32 v10, v213, v212
    v_xor_b32 v214, 64, v212
    v_add_u32 v11, v213, v214
    v_add_u32 v11, 13312, v11
    s_lshl_b32 s62, s54, 3
    v_add_u32 v213, s62, v208
    v_mul_u32_u24 v213, 3584, v213
    v_and_b32 v214, 1, v211
    v_lshlrev_b32 v214, 2, v214
    v_xor_b32 v214, v210, v214
    v_lshl_add_u32 v12, v214, 4, v213
    s_waitcnt lgkmcnt(0)
    s_mul_i32 s62, s57, 114688
    s_add_u32 s24, s4, s62
    s_addc_u32 s25, s5, 0
    s_mov_b32 s26, 114688
    s_mov_b32 s27, 0x20000
    s_mov_b32 s28, s12
    s_mov_b32 s29, s13
    s_mov_b32 s30, 1605632
    s_mov_b32 s31, 0x20000
    s_lshl_b32 s64, s54, 11
    s_lshl_b32 s65, s54, 10
    s_lshl_b32 s66, s58, 7
    s_add_u32 s67, s66, 1792
    s_mov_b32 s68, 0
    s_add_u32 s69, s65, 114688
    s_mov_b32 s70, 6

    s_lshl_b32 s62, s57, 1
    s_add_u32 s62, s62, s58
    s_mul_i32 s63, s62, 37
    s_lshr_b32 s63, s63, 8
    s_mul_i32 s63, s63, 7
    s_sub_u32 s62, s62, s63
    s_lshl_b32 s94, s62, 7
    s_mov_b32 s98, s94
    s_mul_i32 s62, s62, 229376
    s_add_u32 s66, s66, s62
    s_add_u32 s67, s67, s62
    s_movk_i32 s96, 896
    s_mov_b32 s97, 1605632

    s_mov_b32 m0, s64
    s_add_u32 s64, s64, 16384
    buffer_load_dwordx4 v10, s[24:27], s94 offen  lds
    buffer_load_dwordx4 v11, s[24:27], s94 offen offset:1024  lds
    s_add_u32 s94, s94, 128
    s_cmp_ge_u32 s94, s96
    s_cselect_b32 s99, s96, 0
    s_sub_u32 s94, s94, s99
    s_add_u32 m0, s65, 114688
    s_nop 0
    buffer_load_dwordx4 v12, s[28:31], s67 offen  lds
    s_add_u32 s67, s67, 229376
    s_cmp_ge_u32 s67, s97
    s_cselect_b32 s99, s97, 0
    s_sub_u32 s67, s67, s99
    s_mov_b32 m0, s64
    s_add_u32 s64, s64, 16384
    buffer_load_dwordx4 v10, s[24:27], s94 offen  lds
    buffer_load_dwordx4 v11, s[24:27], s94 offen offset:1024  lds
    s_add_u32 s94, s94, 128
    s_cmp_ge_u32 s94, s96
    s_cselect_b32 s99, s96, 0
    s_sub_u32 s94, s94, s99
    s_lshr_b32 s62, s54, 2
    s_lshl_b32 s62, s62, 5
    s_lshl_b32 s63, s61, 4
    s_add_u32 s62, s62, s63
    s_and_b32 s63, s60, 1
    s_lshl_b32 s63, s63, 2
    s_add_u32 s62, s62, s63
    v_add_u32 v213, s62, v209
    v_mul_u32_u24 v213, 896, v213
    s_lshl_b32 s63, s61, 6
    v_xor_b32 v214, s63, v212
    v_add_u32 v13, v213, v214
    s_cmp_eq_u32 s59, 0
    s_cselect_b32 s8, s8, s10
    s_cselect_b32 s9, s9, s11
    s_mul_i32 s62, s56, 57344
    s_add_u32 s32, s8, s62
    s_addc_u32 s33, s9, 0
    s_mov_b32 s34, 57344
    s_mov_b32 s35, 0x20000
    s_add_u32 s36, s22, 0
    s_addc_u32 s37, s23, 0
    s_mov_b32 s38, 7340032
    s_mov_b32 s39, 0x20000
    s_add_u32 s40, s22, 8388608
    s_addc_u32 s41, s23, 0
    s_mov_b32 s42, 3670016
    s_mov_b32 s43, 0x20000
    s_mul_i32 s62, s57, 28672
    s_add_u32 s62, s62, 23068672
    s_add_u32 s44, s22, s62
    s_addc_u32 s45, s23, 0
    s_mov_b32 s46, 28672
    s_mov_b32 s47, 0x20000
    s_mov_b32 s48, s20
    s_mov_b32 s49, s21
    s_mov_b32 s50, 256
    s_mov_b32 s51, 0x20000
    s_mov_b32 s68, s98

    v_and_b32 v208, 31, v0
    v_lshrrev_b32 v209, 5, v0
    v_bfe_u32 v210, v0, 1, 3
    v_xor_b32 v210, v210, v209
    v_lshlrev_b32 v210, 4, v210
    v_lshl_add_u32 v210, v208, 7, v210
    s_lshl_b32 s62, s60, 12
    v_add_u32 v4, s62, v210
    v_xor_b32 v5, 32, v4
    v_xor_b32 v6, 64, v4
    v_xor_b32 v7, 96, v4
    v_bfe_u32 v210, v0, 2, 2
    v_lshl_add_u32 v211, v209, 3, v210
    v_lshlrev_b32 v211, 7, v211
    v_lshrrev_b32 v210, 1, v210
    v_xor_b32 v210, s61, v210
    v_lshl_add_u32 v211, v210, 6, v211
    v_bfe_u32 v212, v0, 4, 1
    v_and_b32 v213, 3, v0
    v_lshlrev_b32 v214, 5, v212
    v_lshl_add_u32 v214, v213, 3, v214
    v_add_u32 v8, v211, v214
    v_add_u32 v8, 114688, v8
    v_lshrrev_b32 v214, 1, v213
    v_lshlrev_b32 v214, 5, v214
    v_lshl_add_u32 v214, v212, 4, v214
    v_and_b32 v213, 1, v213
    v_lshl_add_u32 v214, v213, 3, v214
    v_add_u32 v9, v211, v214

    s_lshl_b32 s73, s58, 1
    s_add_u32 s73, s73, s61
    s_lshl_b32 s74, s73, 1

    s_mul_i32 s62, s74, 37
    s_lshr_b32 s62, s62, 8
    s_mul_i32 s63, s62, 7
    s_sub_u32 s63, s74, s63
    s_add_u32 s71, s63, 6
    s_cmp_ge_u32 s71, 7
    s_cselect_b32 s72, 7, 0
    s_sub_u32 s71, s71, s72
    s_bitcmp1_b32 s62, 0
    s_cselect_b32 s63, s71, s63
    s_mul_i32 s62, s62, 458752
    s_lshl_b32 s63, s63, 10
    s_add_u32 s75, s62, s63

    s_add_u32 s74, s74, 1
    s_mul_i32 s62, s74, 37
    s_lshr_b32 s62, s62, 8
    s_mul_i32 s63, s62, 7
    s_sub_u32 s63, s74, s63
    s_add_u32 s71, s63, 6
    s_cmp_ge_u32 s71, 7
    s_cselect_b32 s72, 7, 0
    s_sub_u32 s71, s71, s72
    s_bitcmp1_b32 s62, 0
    s_cselect_b32 s63, s71, s63
    s_mul_i32 s62, s62, 458752
    s_lshl_b32 s63, s63, 10
    s_add_u32 s76, s62, s63

    s_sub_u32 s76, s76, s75
    v_and_b32 v213, 15, v0
    v_lshl_add_u32 v213, v209, 4, v213
    v_lshlrev_b32 v213, 4, v213
    v_mul_lo_u32 v214, v212, s76
    v_add3_u32 v14, v213, v214, s75
    v_mul_u32_u24 v214, 28672, v212
    v_add_u32 v15, v213, v214
    s_lshl_b32 s62, s57, 2
    s_add_u32 s62, s62, s60
    s_mul_i32 s75, s62, 7168
    s_add_u32 s76, s75, 3670016
    s_mul_i32 s77, s62, 57344
    s_lshl_b32 s63, s73, 10
    s_add_u32 s77, s77, s63
    v_bfe_u32 v213, v0, 2, 2
    v_lshlrev_b32 v213, 6, v213
    v_lshl_add_u32 v213, v209, 5, v213
    v_lshl_add_u32 v213, v212, 4, v213
    s_lshl_b32 s62, s60, 8
    s_add_u32 s63, s63, s62
    v_add_u32 v2, s63, v213
    v_lshrrev_b32 v213, 4, v0
    v_lshlrev_b32 v213, 10, v213
    v_and_b32 v214, 15, v0
    v_lshl_add_u32 v213, v214, 4, v213
    v_add_u32 v3, s62, v213
    v_mov_b32 v255, 0xbdd2d3e8
    s_mov_b32 s78, 0x11111111
    s_mov_b32 s79, 0x11111111
    s_sub_u32 s73, s61, s60
    s_lshl_b32 s73, s73, 12

    s_add_u32 m0, s65, 122880
    s_nop 0
    buffer_load_dwordx4 v12, s[28:31], s67 offen  lds
    s_add_u32 s67, s67, 229376
    s_cmp_ge_u32 s67, s97
    s_cselect_b32 s99, s97, 0
    s_sub_u32 s67, s67, s99
    s_waitcnt vmcnt(3)
    s_barrier
    ds_read_b128 v[16:19], v4 offset:0
    ds_read_b64_tr_b16 v[128:129], v8 offset:0
    ds_read_b64_tr_b16 v[130:131], v8 offset:512
    ds_read_b128 v[20:23], v5 offset:0
    ds_read_b64_tr_b16 v[132:133], v8 offset:2048
    ds_read_b64_tr_b16 v[134:135], v8 offset:2560
    ds_read_b128 v[24:27], v6 offset:0
    ds_read_b64_tr_b16 v[136:137], v8 offset:4096
    ds_read_b64_tr_b16 v[138:139], v8 offset:4608
    ds_read_b128 v[28:31], v7 offset:0
    ds_read_b64_tr_b16 v[140:141], v8 offset:6144
    ds_read_b64_tr_b16 v[142:143], v8 offset:6656
    s_mov_b32 m0, s64
    s_add_u32 s64, s64, 16384
    buffer_load_dwordx4 v10, s[24:27], s94 offen  lds
    buffer_load_dwordx4 v11, s[24:27], s94 offen offset:1024  lds
    s_add_u32 s94, s94, 128
    s_cmp_ge_u32 s94, s96
    s_cselect_b32 s99, s96, 0
    s_sub_u32 s94, s94, s99
    s_add_u32 m0, s65, 131072
    s_nop 0
    buffer_load_dwordx4 v12, s[28:31], s67 offen  lds
    s_add_u32 s67, s67, 229376
    s_cmp_ge_u32 s67, s97
    s_cselect_b32 s99, s97, 0
    s_sub_u32 s67, s67, s99
    s_waitcnt lgkmcnt(0)
    s_waitcnt vmcnt(3)
    s_barrier
    v_mfma_f32_32x32x16_bf16 v[160:175], v[16:19], v[128:131], 0
    ds_read_b128 v[32:35], v4 offset:16384
    ds_read_b64_tr_b16 v[144:145], v8 offset:8192
    ds_read_b64_tr_b16 v[146:147], v8 offset:8704
    ds_read_b128 v[36:39], v5 offset:16384
    ds_read_b64_tr_b16 v[148:149], v8 offset:10240
    ds_read_b64_tr_b16 v[150:151], v8 offset:10752
    ds_read_b128 v[40:43], v6 offset:16384
    ds_read_b64_tr_b16 v[152:153], v8 offset:12288
    ds_read_b64_tr_b16 v[154:155], v8 offset:12800
    ds_read_b128 v[44:47], v7 offset:16384
    ds_read_b64_tr_b16 v[156:157], v8 offset:14336
    ds_read_b64_tr_b16 v[158:159], v8 offset:14848
    v_mfma_f32_32x32x16_bf16 v[160:175], v[20:23], v[132:135], v[160:175]
    s_mov_b32 m0, s64
    s_add_u32 s64, s64, 16384
    buffer_load_dwordx4 v10, s[24:27], s94 offen  lds
    buffer_load_dwordx4 v11, s[24:27], s94 offen offset:1024  lds
    s_add_u32 s94, s94, 128
    s_cmp_ge_u32 s94, s96
    s_cselect_b32 s99, s96, 0
    s_sub_u32 s94, s94, s99
    s_add_u32 m0, s65, 139264
    s_nop 0
    buffer_load_dwordx4 v12, s[28:31], s67 offen  lds
    s_add_u32 s67, s67, 229376
    s_cmp_ge_u32 s67, s97
    s_cselect_b32 s99, s97, 0
    s_sub_u32 s67, s67, s99
    v_mfma_f32_32x32x16_bf16 v[160:175], v[24:27], v[136:139], v[160:175]
    v_mfma_f32_32x32x16_bf16 v[160:175], v[28:31], v[140:143], v[160:175]
    s_waitcnt lgkmcnt(0)
    s_waitcnt vmcnt(3)
    s_barrier
    v_mfma_f32_32x32x16_bf16 v[160:175], v[32:35], v[144:147], v[160:175]
    ds_read_b128 v[48:51], v4 offset:32768
    ds_read_b64_tr_b16 v[128:129], v8 offset:16384
    ds_read_b64_tr_b16 v[130:131], v8 offset:16896
    ds_read_b128 v[52:55], v5 offset:32768
    ds_read_b64_tr_b16 v[132:133], v8 offset:18432
    ds_read_b64_tr_b16 v[134:135], v8 offset:18944
    ds_read_b128 v[56:59], v6 offset:32768
    ds_read_b64_tr_b16 v[136:137], v8 offset:20480
    ds_read_b64_tr_b16 v[138:139], v8 offset:20992
    ds_read_b128 v[60:63], v7 offset:32768
    ds_read_b64_tr_b16 v[140:141], v8 offset:22528
    ds_read_b64_tr_b16 v[142:143], v8 offset:23040
    v_mfma_f32_32x32x16_bf16 v[160:175], v[36:39], v[148:151], v[160:175]
    s_mov_b32 m0, s64
    s_add_u32 s64, s64, 16384
    buffer_load_dwordx4 v10, s[24:27], s94 offen  lds
    buffer_load_dwordx4 v11, s[24:27], s94 offen offset:1024  lds
    s_add_u32 s94, s94, 128
    s_cmp_ge_u32 s94, s96
    s_cselect_b32 s99, s96, 0
    s_sub_u32 s94, s94, s99
    s_add_u32 m0, s65, 147456
    s_nop 0
    buffer_load_dwordx4 v12, s[28:31], s67 offen  lds
    s_add_u32 s67, s67, 229376
    s_cmp_ge_u32 s67, s97
    s_cselect_b32 s99, s97, 0
    s_sub_u32 s67, s67, s99
    v_mfma_f32_32x32x16_bf16 v[160:175], v[40:43], v[152:155], v[160:175]
    v_mfma_f32_32x32x16_bf16 v[160:175], v[44:47], v[156:159], v[160:175]
    s_waitcnt lgkmcnt(0)
    s_waitcnt vmcnt(3)
    s_barrier
    v_mfma_f32_32x32x16_bf16 v[160:175], v[48:51], v[128:131], v[160:175]
    ds_read_b128 v[64:67], v4 offset:49152
    ds_read_b64_tr_b16 v[144:145], v8 offset:24576
    ds_read_b64_tr_b16 v[146:147], v8 offset:25088
    ds_read_b128 v[68:71], v5 offset:49152
    ds_read_b64_tr_b16 v[148:149], v8 offset:26624
    ds_read_b64_tr_b16 v[150:151], v8 offset:27136
    ds_read_b128 v[72:75], v6 offset:49152
    ds_read_b64_tr_b16 v[152:153], v8 offset:28672
    ds_read_b64_tr_b16 v[154:155], v8 offset:29184
    ds_read_b128 v[76:79], v7 offset:49152
    ds_read_b64_tr_b16 v[156:157], v8 offset:30720
    ds_read_b64_tr_b16 v[158:159], v8 offset:31232
    v_mfma_f32_32x32x16_bf16 v[160:175], v[52:55], v[132:135], v[160:175]
    s_mov_b32 m0, s64
    s_add_u32 s64, s64, 16384
    buffer_load_dwordx4 v10, s[24:27], s94 offen  lds
    buffer_load_dwordx4 v11, s[24:27], s94 offen offset:1024  lds
    s_add_u32 s94, s94, 128
    s_cmp_ge_u32 s94, s96
    s_cselect_b32 s99, s96, 0
    s_sub_u32 s94, s94, s99
    s_add_u32 m0, s65, 155648
    s_nop 0
    buffer_load_dwordx4 v12, s[28:31], s67 offen  lds
    s_add_u32 s67, s67, 229376
    s_cmp_ge_u32 s67, s97
    s_cselect_b32 s99, s97, 0
    s_sub_u32 s67, s67, s99
    v_mfma_f32_32x32x16_bf16 v[160:175], v[56:59], v[136:139], v[160:175]
    v_mfma_f32_32x32x16_bf16 v[160:175], v[60:63], v[140:143], v[160:175]
    s_waitcnt lgkmcnt(0)
    s_waitcnt vmcnt(3)
    s_barrier
    v_add_u32 v4, 0x10000, v4
    v_add_u32 v5, 0x10000, v5
    v_add_u32 v6, 0x10000, v6
    v_add_u32 v7, 0x10000, v7
    v_mfma_f32_32x32x16_bf16 v[160:175], v[64:67], v[144:147], v[160:175]
    ds_read_b128 v[80:83], v4 offset:0
    ds_read_b64_tr_b16 v[128:129], v8 offset:32768
    ds_read_b64_tr_b16 v[130:131], v8 offset:33280
    ds_read_b128 v[84:87], v5 offset:0
    ds_read_b64_tr_b16 v[132:133], v8 offset:34816
    ds_read_b64_tr_b16 v[134:135], v8 offset:35328
    ds_read_b128 v[88:91], v6 offset:0
    ds_read_b64_tr_b16 v[136:137], v8 offset:36864
    ds_read_b64_tr_b16 v[138:139], v8 offset:37376
    ds_read_b128 v[92:95], v7 offset:0
    ds_read_b64_tr_b16 v[140:141], v8 offset:38912
    ds_read_b64_tr_b16 v[142:143], v8 offset:39424
    v_mfma_f32_32x32x16_bf16 v[160:175], v[68:71], v[148:151], v[160:175]
    s_mov_b32 m0, s64
    s_add_u32 s64, s64, 16384
    buffer_load_dwordx4 v10, s[24:27], s94 offen  lds
    buffer_load_dwordx4 v11, s[24:27], s94 offen offset:1024  lds
    s_add_u32 s94, s94, 128
    s_cmp_ge_u32 s94, s96
    s_cselect_b32 s99, s96, 0
    s_sub_u32 s94, s94, s99
    s_add_u32 m0, s65, 0
    s_nop 0
    buffer_load_dwordx4 v12, s[28:31], s67 offen  lds
    s_add_u32 s67, s67, 229376
    s_cmp_ge_u32 s67, s97
    s_cselect_b32 s99, s97, 0
    s_sub_u32 s67, s67, s99
    v_mfma_f32_32x32x16_bf16 v[160:175], v[72:75], v[152:155], v[160:175]
    v_mfma_f32_32x32x16_bf16 v[160:175], v[76:79], v[156:159], v[160:175]
    s_waitcnt lgkmcnt(0)
    s_waitcnt vmcnt(3)
    s_barrier
    v_mfma_f32_32x32x16_bf16 v[160:175], v[80:83], v[128:131], v[160:175]
    ds_read_b128 v[96:99], v4 offset:16384
    ds_read_b64_tr_b16 v[144:145], v8 offset:40960
    ds_read_b64_tr_b16 v[146:147], v8 offset:41472
    ds_read_b128 v[100:103], v5 offset:16384
    ds_read_b64_tr_b16 v[148:149], v8 offset:43008
    ds_read_b64_tr_b16 v[150:151], v8 offset:43520
    ds_read_b128 v[104:107], v6 offset:16384
    ds_read_b64_tr_b16 v[152:153], v8 offset:45056
    ds_read_b64_tr_b16 v[154:155], v8 offset:45568
    ds_read_b128 v[108:111], v7 offset:16384
    ds_read_b64_tr_b16 v[156:157], v8 offset:47104
    ds_read_b64_tr_b16 v[158:159], v8 offset:47616
    v_mfma_f32_32x32x16_bf16 v[160:175], v[84:87], v[132:135], v[160:175]
    s_add_u32 m0, s65, 8192
    s_nop 0
    buffer_load_dwordx4 v12, s[28:31], s66 offen  lds
    s_add_u32 s66, s66, 229376
    s_cmp_ge_u32 s66, s97
    s_cselect_b32 s99, s97, 0
    s_sub_u32 s66, s66, s99
    s_add_u32 m0, s65, 16384
    s_nop 0
    buffer_load_dwordx4 v12, s[28:31], s66 offen  lds
    s_add_u32 s66, s66, 229376
    s_cmp_ge_u32 s66, s97
    s_cselect_b32 s99, s97, 0
    s_sub_u32 s66, s66, s99
    s_add_u32 m0, s65, 24576
    s_nop 0
    buffer_load_dwordx4 v12, s[28:31], s66 offen  lds
    s_add_u32 s66, s66, 229376
    s_cmp_ge_u32 s66, s97
    s_cselect_b32 s99, s97, 0
    s_sub_u32 s66, s66, s99
    v_mfma_f32_32x32x16_bf16 v[160:175], v[88:91], v[136:139], v[160:175]
    v_mfma_f32_32x32x16_bf16 v[160:175], v[92:95], v[140:143], v[160:175]
    s_waitcnt lgkmcnt(0)
    s_waitcnt vmcnt(3)
    s_barrier
    v_add_u32 v8, 0xfffe4000, v8
    v_mfma_f32_32x32x16_bf16 v[160:175], v[96:99], v[144:147], v[160:175]
    ds_read_b128 v[112:115], v4 offset:32768
    ds_read_b64_tr_b16 v[128:129], v8 offset:0
    ds_read_b64_tr_b16 v[130:131], v8 offset:512
    ds_read_b128 v[116:119], v5 offset:32768
    ds_read_b64_tr_b16 v[132:133], v8 offset:2048
    ds_read_b64_tr_b16 v[134:135], v8 offset:2560
    ds_read_b128 v[120:123], v6 offset:32768
    ds_read_b64_tr_b16 v[136:137], v8 offset:4096
    ds_read_b64_tr_b16 v[138:139], v8 offset:4608
    ds_read_b128 v[124:127], v7 offset:32768
    ds_read_b64_tr_b16 v[140:141], v8 offset:6144
    ds_read_b64_tr_b16 v[142:143], v8 offset:6656
    v_mfma_f32_32x32x16_bf16 v[160:175], v[100:103], v[148:151], v[160:175]
    s_add_u32 m0, s65, 32768
    s_nop 0
    buffer_load_dwordx4 v12, s[28:31], s66 offen  lds
    s_add_u32 s66, s66, 229376
    s_cmp_ge_u32 s66, s97
    s_cselect_b32 s99, s97, 0
    s_sub_u32 s66, s66, s99
    s_add_u32 m0, s65, 40960
    s_nop 0
    buffer_load_dwordx4 v12, s[28:31], s66 offen  lds
    s_add_u32 s66, s66, 229376
    s_cmp_ge_u32 s66, s97
    s_cselect_b32 s99, s97, 0
    s_sub_u32 s66, s66, s99
    s_add_u32 m0, s65, 49152
    s_nop 0
    buffer_load_dwordx4 v12, s[28:31], s66 offen  lds
    s_add_u32 s66, s66, 229376
    s_cmp_ge_u32 s66, s97
    s_cselect_b32 s99, s97, 0
    s_sub_u32 s66, s66, s99
    s_add_u32 m0, s65, 57344
    s_nop 0
    buffer_load_dwordx4 v12, s[28:31], s66 offen  lds
    s_add_u32 s66, s66, 229376
    s_cmp_ge_u32 s66, s97
    s_cselect_b32 s99, s97, 0
    s_sub_u32 s66, s66, s99
    s_mov_b32 s95, 0x01010101
    s_mov_b32 s70, 5000
    v_and_b32 v193, 7, v0
    v_lshlrev_b32 v193, 2, v193
    v_lshl_add_u32 v193, s54, 8, v193
    buffer_load_dword v192, v193, s[48:51], 0 offen sc1
    v_mfma_f32_32x32x16_bf16 v[160:175], v[104:107], v[152:155], v[160:175]
    v_mfma_f32_32x32x16_bf16 v[160:175], v[108:111], v[156:159], v[160:175]
    s_waitcnt lgkmcnt(0)
    s_waitcnt vmcnt(6)
    s_barrier
    v_add_u32 v4, s73, v4
    v_add_u32 v5, s73, v5
    v_add_u32 v6, s73, v6
    v_add_u32 v7, s73, v7
    v_mfma_f32_32x32x16_bf16 v[160:175], v[112:115], v[128:131], v[160:175]
    ds_read_b64_tr_b16 v[144:145], v9 offset:8192
    ds_read_b64_tr_b16 v[146:147], v9 offset:8704
    ds_read_b64_tr_b16 v[148:149], v9 offset:10240
    v_mfma_f32_32x32x16_bf16 v[160:175], v[116:119], v[132:135], v[160:175]
    ds_read_b64_tr_b16 v[150:151], v9 offset:10752
    ds_read_b64_tr_b16 v[152:153], v9 offset:12288
    ds_read_b64_tr_b16 v[154:155], v9 offset:12800
    v_mfma_f32_32x32x16_bf16 v[160:175], v[120:123], v[136:139], v[160:175]
    ds_read_b64_tr_b16 v[156:157], v9 offset:14336
    ds_read_b64_tr_b16 v[158:159], v9 offset:14848
    s_add_u32 m0, s65, 65536
    s_nop 0
    buffer_load_dwordx4 v13, s[32:35], s68 offen  lds
    s_add_u32 s68, s68, 128
    s_cmp_ge_u32 s68, s96
    s_cselect_b32 s99, s96, 0
    s_sub_u32 s68, s68, s99
    s_add_u32 m0, s65, 73728
    s_nop 0
    buffer_load_dwordx4 v13, s[32:35], s68 offen  lds
    s_add_u32 s68, s68, 128
    s_cmp_ge_u32 s68, s96
    s_cselect_b32 s99, s96, 0
    s_sub_u32 s68, s68, s99
    s_add_u32 m0, s65, 81920
    s_nop 0
    buffer_load_dwordx4 v13, s[32:35], s68 offen  lds
    s_add_u32 s68, s68, 128
    s_cmp_ge_u32 s68, s96
    s_cselect_b32 s99, s96, 0
    s_sub_u32 s68, s68, s99
    s_add_u32 m0, s65, 90112
    s_nop 0
    buffer_load_dwordx4 v13, s[32:35], s68 offen  lds
    s_add_u32 s68, s68, 128
    s_cmp_ge_u32 s68, s96
    s_cselect_b32 s99, s96, 0
    s_sub_u32 s68, s68, s99
    v_mfma_f32_32x32x16_bf16 v[160:175], v[124:127], v[140:143], v[160:175]
    s_waitcnt lgkmcnt(0)
    s_load_dwordx4 s[4:7], s[0:1], 8
    s_load_dwordx2 s[8:9], s[0:1], 56

    v_mfma_f32_32x32x16_bf16 v[176:191], v[144:147], v[16:19], 0
    ds_read_b64_tr_b16 v[128:129], v9 offset:16384
    ds_read_b64_tr_b16 v[130:131], v9 offset:16896
    ds_read_b64_tr_b16 v[132:133], v9 offset:18432
    v_mfma_f32_32x32x16_bf16 v[176:191], v[148:151], v[20:23], v[176:191]
    ds_read_b64_tr_b16 v[134:135], v9 offset:18944
    ds_read_b64_tr_b16 v[136:137], v9 offset:20480
    ds_read_b64_tr_b16 v[138:139], v9 offset:20992
    s_nop 0
    v_mul_f32 v208, v160, v160
    v_mul_f32 v209, v161, v161
    v_mul_f32 v210, v162, v162
    v_mul_f32 v211, v163, v163
    v_fmaak_f32 v208, v255, v208, 0xc0135761
    v_fmaak_f32 v209, v255, v209, 0xc0135761
    v_fmaak_f32 v210, v255, v210, 0xc0135761
    v_fmaak_f32 v211, v255, v211, 0xc0135761
    v_mul_f32 v208, v208, v160
    v_mul_f32 v209, v209, v161
    v_mul_f32 v210, v210, v162
    v_mul_f32 v211, v211, v163
    v_exp_f32 v208, v208
    v_exp_f32 v209, v209
    v_exp_f32 v210, v210
    v_exp_f32 v211, v211
    v_add_f32 v208, 1.0, v208
    v_add_f32 v209, 1.0, v209
    v_add_f32 v210, 1.0, v210
    v_add_f32 v211, 1.0, v211
    v_rcp_f32 v208, v208
    v_rcp_f32 v209, v209
    v_rcp_f32 v210, v210
    v_rcp_f32 v211, v211
    v_mul_f32 v160, v160, v208
    v_mul_f32 v161, v161, v209
    v_mul_f32 v162, v162, v210
    v_mul_f32 v163, v163, v211
    v_mul_f32 v212, v164, v164
    v_mfma_f32_32x32x16_bf16 v[176:191], v[152:155], v[24:27], v[176:191]
    ds_read_b64_tr_b16 v[140:141], v9 offset:22528
    ds_read_b64_tr_b16 v[142:143], v9 offset:23040
    s_add_u32 m0, s65, 98304
    s_nop 0
    buffer_load_dwordx4 v13, s[32:35], s68 offen  lds
    s_add_u32 s68, s68, 128
    s_cmp_ge_u32 s68, s96
    s_cselect_b32 s99, s96, 0
    s_sub_u32 s68, s68, s99
    s_add_u32 m0, s65, 106496
    s_nop 0
    buffer_load_dwordx4 v13, s[32:35], s68 offen  lds
    s_add_u32 s68, s68, 128
    s_cmp_ge_u32 s68, s96
    s_cselect_b32 s99, s96, 0
    s_sub_u32 s68, s68, s99
    s_add_u32 m0, s65, 114688
    s_nop 0
    buffer_load_dwordx4 v13, s[32:35], s68 offen  lds
    s_add_u32 s68, s68, 128
    s_cmp_ge_u32 s68, s96
    s_cselect_b32 s99, s96, 0
    s_sub_u32 s68, s68, s99
    v_mul_f32 v213, v165, v165
    v_mul_f32 v214, v166, v166
    v_mul_f32 v215, v167, v167
    v_fmaak_f32 v212, v255, v212, 0xc0135761
    v_fmaak_f32 v213, v255, v213, 0xc0135761
    v_fmaak_f32 v214, v255, v214, 0xc0135761
    v_fmaak_f32 v215, v255, v215, 0xc0135761
    v_mul_f32 v212, v212, v164
    v_mul_f32 v213, v213, v165
    v_mul_f32 v214, v214, v166
    v_mul_f32 v215, v215, v167
    v_exp_f32 v212, v212
    v_exp_f32 v213, v213
    v_exp_f32 v214, v214
    v_exp_f32 v215, v215
    v_add_f32 v212, 1.0, v212
    v_add_f32 v213, 1.0, v213
    v_add_f32 v214, 1.0, v214
    v_add_f32 v215, 1.0, v215
    v_rcp_f32 v212, v212
    v_rcp_f32 v213, v213
    v_rcp_f32 v214, v214
    v_rcp_f32 v215, v215
    v_mul_f32 v164, v164, v212
    v_mul_f32 v165, v165, v213
    v_mul_f32 v166, v166, v214
    v_mul_f32 v167, v167, v215
    v_mul_f32 v208, v168, v168
    v_mfma_f32_32x32x16_bf16 v[176:191], v[156:159], v[28:31], v[176:191]
    v_mul_f32 v209, v169, v169
    v_mul_f32 v210, v170, v170
    v_mul_f32 v211, v171, v171
    v_fmaak_f32 v208, v255, v208, 0xc0135761
    v_fmaak_f32 v209, v255, v209, 0xc0135761
    v_fmaak_f32 v210, v255, v210, 0xc0135761
    v_fmaak_f32 v211, v255, v211, 0xc0135761
    v_mul_f32 v208, v208, v168
    v_mul_f32 v209, v209, v169
    v_mul_f32 v210, v210, v170
    v_mul_f32 v211, v211, v171
    v_exp_f32 v208, v208
    v_exp_f32 v209, v209
    v_exp_f32 v210, v210
    v_exp_f32 v211, v211
    v_add_f32 v208, 1.0, v208
    v_add_f32 v209, 1.0, v209
    v_add_f32 v210, 1.0, v210
    v_add_f32 v211, 1.0, v211
    v_rcp_f32 v208, v208
    v_rcp_f32 v209, v209
    v_rcp_f32 v210, v210
    v_rcp_f32 v211, v211
    v_mul_f32 v168, v168, v208
    v_mul_f32 v169, v169, v209
    v_mul_f32 v170, v170, v210
    v_mul_f32 v171, v171, v211
    v_mul_f32 v212, v172, v172
    s_waitcnt lgkmcnt(0)
    s_cmp_lg_u32 s54, 0
    s_cbranch_scc1 L_k1ok_5
    s_waitcnt vmcnt(7)
L_k1poll_4:
    v_cmp_ne_u32 vcc, s95, v192
    s_cbranch_vccz L_k1ok_5
    s_sleep 8
    buffer_load_dword v192, v193, s[48:51], 0 offen sc1

    s_sub_u32 s70, s70, 1
    s_cmp_lg_u32 s70, 0
    s_waitcnt vmcnt(0)
    s_cbranch_scc1 L_k1poll_4

L_k1ok_5:
    s_waitcnt vmcnt(10)
    s_barrier
    s_lshl_b32 s62, s53, 3
    s_add_u32 s62, s62, s54
    s_mov_b32 s10, 0x800000
    s_mov_b32 s11, 0x20000
    s_cmp_ge_u32 s52, 4
    s_cbranch_scc1 L_k1pr1_6
    s_lshl_b32 s62, s62, 13
    s_lshl_b32 s63, s52, 21
    s_add_u32 s62, s62, s63
    v_and_b32 v253, 31, v0
    v_min_u32 v253, 7, v253

    v_lshrrev_b32 v1, 5, v0
    v_lshlrev_b32 v1, 12, v1
    v_lshl_add_u32 v1, v253, 7, v1
    buffer_load_dword v254, v1, s[8:11], s62 offen offset:0
    s_branch L_k1pe_7

L_k1pr1_6:
    s_bitcmp1_b32 s52, 1
    s_cselect_b32 s4, s6, s4
    s_cselect_b32 s5, s7, s5
    s_cmp_ge_u32 s52, 4
    s_cselect_b32 s8, s4, s8
    s_cselect_b32 s9, s5, s9
    s_lshl_b32 s62, s62, 14
    s_and_b32 s63, s52, 1
    s_lshl_b32 s63, s63, 22
    s_add_u32 s62, s62, s63
    v_and_b32 v253, 15, v0
    v_min_u32 v253, 7, v253

    v_lshrrev_b32 v1, 4, v0
    v_lshlrev_b32 v1, 12, v1
    v_lshl_add_u32 v1, v253, 7, v1
    buffer_load_dword v254, v1, s[8:11], s62 offen offset:0

L_k1pe_7:
    v_mfma_f32_32x32x16_bf16 v[176:191], v[128:131], v[32:35], v[176:191]
    ds_read_b64_tr_b16 v[144:145], v9 offset:24576
    ds_read_b64_tr_b16 v[146:147], v9 offset:25088
    ds_read_b64_tr_b16 v[148:149], v9 offset:26624
    v_mul_f32 v213, v173, v173
    v_mul_f32 v214, v174, v174
    v_mul_f32 v215, v175, v175
    v_fmaak_f32 v212, v255, v212, 0xc0135761
    v_fmaak_f32 v213, v255, v213, 0xc0135761
    v_fmaak_f32 v214, v255, v214, 0xc0135761
    v_fmaak_f32 v215, v255, v215, 0xc0135761
    v_mul_f32 v212, v212, v172
    v_mul_f32 v213, v213, v173
    v_mul_f32 v214, v214, v174
    v_mul_f32 v215, v215, v175
    v_exp_f32 v212, v212
    v_exp_f32 v213, v213
    v_exp_f32 v214, v214
    v_exp_f32 v215, v215
    v_add_f32 v212, 1.0, v212
    v_add_f32 v213, 1.0, v213
    v_add_f32 v214, 1.0, v214
    v_add_f32 v215, 1.0, v215
    v_rcp_f32 v212, v212
    v_rcp_f32 v213, v213
    v_rcp_f32 v214, v214
    v_rcp_f32 v215, v215
    v_mul_f32 v172, v172, v212
    v_mul_f32 v173, v173, v213
    v_mul_f32 v174, v174, v214
    v_mul_f32 v175, v175, v215
    v_mul_f32 v216, v160, v160
    v_mfma_f32_32x32x16_bf16 v[176:191], v[132:135], v[36:39], v[176:191]
    ds_read_b64_tr_b16 v[150:151], v9 offset:27136
    ds_read_b64_tr_b16 v[152:153], v9 offset:28672
    ds_read_b64_tr_b16 v[154:155], v9 offset:29184
    v_mul_f32 v217, v161, v161
    v_mul_f32 v218, v162, v162
    v_mul_f32 v219, v163, v163
    v_mul_f32 v220, v164, v164
    v_mul_f32 v221, v165, v165
    v_mul_f32 v222, v166, v166
    v_mul_f32 v223, v167, v167
    v_mul_f32 v224, v168, v168
    v_mul_f32 v225, v169, v169
    v_mul_f32 v226, v170, v170
    v_mul_f32 v227, v171, v171
    v_mul_f32 v228, v172, v172
    v_mul_f32 v229, v173, v173
    v_mul_f32 v230, v174, v174
    v_mul_f32 v231, v175, v175
    v_add_f32_dpp v232, v160, v160 row_ror:8 row_mask:0xf bank_mask:0x3
    v_add_f32_dpp v240, v216, v216 row_ror:8 row_mask:0xf bank_mask:0x3
    v_add_f32_dpp v233, v161, v161 row_ror:8 row_mask:0xf bank_mask:0x3
    v_add_f32_dpp v241, v217, v217 row_ror:8 row_mask:0xf bank_mask:0x3
    v_add_f32_dpp v234, v162, v162 row_ror:8 row_mask:0xf bank_mask:0x3
    v_add_f32_dpp v242, v218, v218 row_ror:8 row_mask:0xf bank_mask:0x3
    v_add_f32_dpp v235, v163, v163 row_ror:8 row_mask:0xf bank_mask:0x3
    v_add_f32_dpp v243, v219, v219 row_ror:8 row_mask:0xf bank_mask:0x3
    v_add_f32_dpp v236, v164, v164 row_ror:8 row_mask:0xf bank_mask:0x3
    v_add_f32_dpp v244, v220, v220 row_ror:8 row_mask:0xf bank_mask:0x3
    v_add_f32_dpp v237, v165, v165 row_ror:8 row_mask:0xf bank_mask:0x3
    v_add_f32_dpp v245, v221, v221 row_ror:8 row_mask:0xf bank_mask:0x3
    v_add_f32_dpp v238, v166, v166 row_ror:8 row_mask:0xf bank_mask:0x3
    v_mfma_f32_32x32x16_bf16 v[176:191], v[136:139], v[40:43], v[176:191]
    ds_read_b64_tr_b16 v[156:157], v9 offset:30720
    ds_read_b64_tr_b16 v[158:159], v9 offset:31232
    v_add_f32_dpp v246, v222, v222 row_ror:8 row_mask:0xf bank_mask:0x3
    v_add_f32_dpp v239, v167, v167 row_ror:8 row_mask:0xf bank_mask:0x3
    v_add_f32_dpp v247, v223, v223 row_ror:8 row_mask:0xf bank_mask:0x3
    v_add_f32_dpp v232, v168, v168 row_ror:8 row_mask:0xf bank_mask:0xc
    v_add_f32_dpp v240, v224, v224 row_ror:8 row_mask:0xf bank_mask:0xc
    v_add_f32_dpp v233, v169, v169 row_ror:8 row_mask:0xf bank_mask:0xc
    v_add_f32_dpp v241, v225, v225 row_ror:8 row_mask:0xf bank_mask:0xc
    v_add_f32_dpp v234, v170, v170 row_ror:8 row_mask:0xf bank_mask:0xc
    v_add_f32_dpp v242, v226, v226 row_ror:8 row_mask:0xf bank_mask:0xc
    v_add_f32_dpp v235, v171, v171 row_ror:8 row_mask:0xf bank_mask:0xc
    v_add_f32_dpp v243, v227, v227 row_ror:8 row_mask:0xf bank_mask:0xc
    v_add_f32_dpp v236, v172, v172 row_ror:8 row_mask:0xf bank_mask:0xc
    v_add_f32_dpp v244, v228, v228 row_ror:8 row_mask:0xf bank_mask:0xc
    v_add_f32_dpp v237, v173, v173 row_ror:8 row_mask:0xf bank_mask:0xc
    v_add_f32_dpp v245, v229, v229 row_ror:8 row_mask:0xf bank_mask:0xc
    v_add_f32_dpp v238, v174, v174 row_ror:8 row_mask:0xf bank_mask:0xc
    v_add_f32_dpp v246, v230, v230 row_ror:8 row_mask:0xf bank_mask:0xc
    v_add_f32_dpp v239, v175, v175 row_ror:8 row_mask:0xf bank_mask:0xc
    v_add_f32_dpp v247, v231, v231 row_ror:8 row_mask:0xf bank_mask:0xc
    v_add_f32_dpp v232, v232, v232 row_half_mirror row_mask:0xf bank_mask:0x5
    v_add_f32_dpp v240, v240, v240 row_half_mirror row_mask:0xf bank_mask:0x5
    v_add_f32_dpp v233, v233, v233 row_half_mirror row_mask:0xf bank_mask:0x5
    v_add_f32_dpp v241, v241, v241 row_half_mirror row_mask:0xf bank_mask:0x5
    v_add_f32_dpp v234, v234, v234 row_half_mirror row_mask:0xf bank_mask:0x5
    v_add_f32_dpp v242, v242, v242 row_half_mirror row_mask:0xf bank_mask:0x5
    v_add_f32_dpp v235, v235, v235 row_half_mirror row_mask:0xf bank_mask:0x5
    v_add_f32_dpp v243, v243, v243 row_half_mirror row_mask:0xf bank_mask:0x5
    v_add_f32_dpp v232, v236, v236 row_half_mirror row_mask:0xf bank_mask:0xa
    v_mfma_f32_32x32x16_bf16 v[176:191], v[140:143], v[44:47], v[176:191]
    v_add_f32_dpp v240, v244, v244 row_half_mirror row_mask:0xf bank_mask:0xa
    v_add_f32_dpp v233, v237, v237 row_half_mirror row_mask:0xf bank_mask:0xa
    v_add_f32_dpp v241, v245, v245 row_half_mirror row_mask:0xf bank_mask:0xa
    v_add_f32_dpp v234, v238, v238 row_half_mirror row_mask:0xf bank_mask:0xa
    v_add_f32_dpp v242, v246, v246 row_half_mirror row_mask:0xf bank_mask:0xa
    v_add_f32_dpp v235, v239, v239 row_half_mirror row_mask:0xf bank_mask:0xa
    v_add_f32_dpp v243, v247, v247 row_half_mirror row_mask:0xf bank_mask:0xa
    v_permlane16_swap_b32 v232, v234
    v_permlane16_swap_b32 v240, v242
    v_permlane16_swap_b32 v233, v235
    v_permlane16_swap_b32 v241, v243
    v_add_f32 v232, v232, v234
    v_add_f32 v240, v240, v242
    v_add_f32 v233, v233, v235
    v_add_f32 v241, v241, v243
    v_add_f32_dpp v232, v232, v232 quad_perm:[1,0,3,2] row_mask:0xf bank_mask:0xf
    v_add_f32_dpp v240, v240, v240 quad_perm:[1,0,3,2] row_mask:0xf bank_mask:0xf
    v_add_f32_dpp v233, v233, v233 quad_perm:[1,0,3,2] row_mask:0xf bank_mask:0xf
    v_add_f32_dpp v241, v241, v241 quad_perm:[1,0,3,2] row_mask:0xf bank_mask:0xf
    v_add_f32_dpp v232, v232, v232 quad_perm:[2,3,0,1] row_mask:0xf bank_mask:0xf
    v_add_f32_dpp v240, v240, v240 quad_perm:[2,3,0,1] row_mask:0xf bank_mask:0xf
    v_add_f32_dpp v233, v233, v233 quad_perm:[2,3,0,1] row_mask:0xf bank_mask:0xf
    v_add_f32_dpp v241, v241, v241 quad_perm:[2,3,0,1] row_mask:0xf bank_mask:0xf
    v_mov_b32 v248, v232
    v_mov_b32 v249, v240
    v_mov_b32 v250, v233
    v_mov_b32 v251, v241
    s_mov_b64 exec, s[78:79]
    buffer_store_dwordx4 v[248:251], v2, s[44:47], 0 offen sc1
    s_mov_b64 exec, -1
    s_waitcnt lgkmcnt(0)
    v_mfma_f32_32x32x16_bf16 v[176:191], v[144:147], v[48:51], v[176:191]
    ds_read_b64_tr_b16 v[128:129], v9 offset:32768
    ds_read_b64_tr_b16 v[130:131], v9 offset:33280
    ds_read_b64_tr_b16 v[132:133], v9 offset:34816
    v_mfma_f32_32x32x16_bf16 v[176:191], v[148:151], v[52:55], v[176:191]
    ds_read_b64_tr_b16 v[134:135], v9 offset:35328
    ds_read_b64_tr_b16 v[136:137], v9 offset:36864
    ds_read_b64_tr_b16 v[138:139], v9 offset:37376
    v_mfma_f32_32x32x16_bf16 v[176:191], v[152:155], v[56:59], v[176:191]
    ds_read_b64_tr_b16 v[140:141], v9 offset:38912
    ds_read_b64_tr_b16 v[142:143], v9 offset:39424
    v_mfma_f32_32x32x16_bf16 v[176:191], v[156:159], v[60:63], v[176:191]
    s_waitcnt lgkmcnt(0)
    v_mfma_f32_32x32x16_bf16 v[176:191], v[128:131], v[64:67], v[176:191]
    ds_read_b64_tr_b16 v[144:145], v9 offset:40960
    ds_read_b64_tr_b16 v[146:147], v9 offset:41472
    ds_read_b64_tr_b16 v[148:149], v9 offset:43008
    v_mfma_f32_32x32x16_bf16 v[176:191], v[132:135], v[68:71], v[176:191]
    ds_read_b64_tr_b16 v[150:151], v9 offset:43520
    ds_read_b64_tr_b16 v[152:153], v9 offset:45056
    ds_read_b64_tr_b16 v[154:155], v9 offset:45568
    v_mfma_f32_32x32x16_bf16 v[176:191], v[136:139], v[72:75], v[176:191]
    ds_read_b64_tr_b16 v[156:157], v9 offset:47104
    ds_read_b64_tr_b16 v[158:159], v9 offset:47616
    v_mfma_f32_32x32x16_bf16 v[176:191], v[140:143], v[76:79], v[176:191]
    s_waitcnt lgkmcnt(0)
    s_waitcnt vmcnt(8)
    s_barrier
    v_mfma_f32_32x32x16_bf16 v[176:191], v[144:147], v[80:83], v[176:191]
    ds_read_b64_tr_b16 v[128:129], v9 offset:49152
    ds_read_b64_tr_b16 v[130:131], v9 offset:49664
    ds_read_b64_tr_b16 v[132:133], v9 offset:51200
    v_mfma_f32_32x32x16_bf16 v[176:191], v[148:151], v[84:87], v[176:191]
    ds_read_b64_tr_b16 v[134:135], v9 offset:51712
    ds_read_b64_tr_b16 v[136:137], v9 offset:53248
    ds_read_b64_tr_b16 v[138:139], v9 offset:53760
    v_mfma_f32_32x32x16_bf16 v[176:191], v[152:155], v[88:91], v[176:191]
    ds_read_b64_tr_b16 v[140:141], v9 offset:55296
    ds_read_b64_tr_b16 v[142:143], v9 offset:55808
    v_mfma_f32_32x32x16_bf16 v[176:191], v[156:159], v[92:95], v[176:191]
    s_waitcnt lgkmcnt(0)
    v_mfma_f32_32x32x16_bf16 v[176:191], v[128:131], v[96:99], v[176:191]
    ds_read_b64_tr_b16 v[144:145], v9 offset:57344
    ds_read_b64_tr_b16 v[146:147], v9 offset:57856
    ds_read_b64_tr_b16 v[148:149], v9 offset:59392
    v_mfma_f32_32x32x16_bf16 v[176:191], v[132:135], v[100:103], v[176:191]
    ds_read_b64_tr_b16 v[150:151], v9 offset:59904
    ds_read_b64_tr_b16 v[152:153], v9 offset:61440
    ds_read_b64_tr_b16 v[154:155], v9 offset:61952
    v_mfma_f32_32x32x16_bf16 v[176:191], v[136:139], v[104:107], v[176:191]
    ds_read_b64_tr_b16 v[156:157], v9 offset:63488
    ds_read_b64_tr_b16 v[158:159], v9 offset:64000
    v_mfma_f32_32x32x16_bf16 v[176:191], v[140:143], v[108:111], v[176:191]
    s_waitcnt lgkmcnt(0)
    v_mfma_f32_32x32x16_bf16 v[176:191], v[144:147], v[112:115], v[176:191]
    ds_read_b128 v[128:131], v4 offset:0
    ds_read_b128 v[132:135], v5 offset:0
    v_mfma_f32_32x32x16_bf16 v[176:191], v[148:151], v[116:119], v[176:191]
    ds_read_b128 v[136:139], v6 offset:0
    v_mfma_f32_32x32x16_bf16 v[176:191], v[152:155], v[120:123], v[176:191]
    ds_read_b128 v[140:143], v7 offset:0
    v_mfma_f32_32x32x16_bf16 v[176:191], v[156:159], v[124:127], v[176:191]
    s_waitcnt lgkmcnt(0)
    s_waitcnt vmcnt(2)
    s_barrier
    v_mfma_f32_32x32x16_bf16 v[192:207], v[16:19], v[128:131], 0
    ds_read_b128 v[144:147], v4 offset:8192
    ds_read_b128 v[148:151], v5 offset:8192
    v_mfma_f32_32x32x16_bf16 v[192:207], v[20:23], v[132:135], v[192:207]
    ds_read_b128 v[152:155], v6 offset:8192
    s_nop 3
    v_mul_f32 v208, v176, v176
    v_mul_f32 v209, v177, v177
    v_mul_f32 v210, v178, v178
    v_mul_f32 v211, v179, v179
    v_fmaak_f32 v208, v255, v208, 0xc0135761
    v_mfma_f32_32x32x16_bf16 v[192:207], v[24:27], v[136:139], v[192:207]
    ds_read_b128 v[156:159], v7 offset:8192
    v_fmaak_f32 v209, v255, v209, 0xc0135761
    v_fmaak_f32 v210, v255, v210, 0xc0135761
    v_fmaak_f32 v211, v255, v211, 0xc0135761
    v_mul_f32 v208, v208, v176
    v_mul_f32 v209, v209, v177
    v_mfma_f32_32x32x16_bf16 v[192:207], v[28:31], v[140:143], v[192:207]
    v_mul_f32 v210, v210, v178
    v_mul_f32 v211, v211, v179
    v_exp_f32 v208, v208
    v_exp_f32 v209, v209
    v_exp_f32 v210, v210
    s_waitcnt lgkmcnt(0)
    v_mfma_f32_32x32x16_bf16 v[192:207], v[32:35], v[144:147], v[192:207]
    ds_read_b128 v[128:131], v4 offset:16384
    ds_read_b128 v[132:135], v5 offset:16384
    v_exp_f32 v211, v211
    v_add_f32 v208, 1.0, v208
    v_add_f32 v209, 1.0, v209
    v_add_f32 v210, 1.0, v210
    v_add_f32 v211, 1.0, v211
    v_mfma_f32_32x32x16_bf16 v[192:207], v[36:39], v[148:151], v[192:207]
    ds_read_b128 v[136:139], v6 offset:16384
    v_rcp_f32 v208, v208
    v_rcp_f32 v209, v209
    v_rcp_f32 v210, v210
    v_rcp_f32 v211, v211
    v_mul_f32 v176, v176, v208
    v_mfma_f32_32x32x16_bf16 v[192:207], v[40:43], v[152:155], v[192:207]
    ds_read_b128 v[140:143], v7 offset:16384
    v_mul_f32 v177, v177, v209
    v_mul_f32 v178, v178, v210
    v_mul_f32 v179, v179, v211
    v_mul_f32 v212, v180, v180
    v_mul_f32 v213, v181, v181
    v_mfma_f32_32x32x16_bf16 v[192:207], v[44:47], v[156:159], v[192:207]
    v_mul_f32 v214, v182, v182
    v_mul_f32 v215, v183, v183
    v_fmaak_f32 v212, v255, v212, 0xc0135761
    v_fmaak_f32 v213, v255, v213, 0xc0135761
    v_fmaak_f32 v214, v255, v214, 0xc0135761
    s_waitcnt lgkmcnt(0)
    v_mfma_f32_32x32x16_bf16 v[192:207], v[48:51], v[128:131], v[192:207]
    ds_read_b128 v[144:147], v4 offset:24576
    ds_read_b128 v[148:151], v5 offset:24576
    v_fmaak_f32 v215, v255, v215, 0xc0135761
    v_mul_f32 v212, v212, v180
    v_mul_f32 v213, v213, v181
    v_mul_f32 v214, v214, v182
    v_mul_f32 v215, v215, v183
    v_mfma_f32_32x32x16_bf16 v[192:207], v[52:55], v[132:135], v[192:207]
    ds_read_b128 v[152:155], v6 offset:24576
    v_exp_f32 v212, v212
    v_exp_f32 v213, v213
    v_exp_f32 v214, v214
    v_exp_f32 v215, v215
    v_add_f32 v212, 1.0, v212
    v_mfma_f32_32x32x16_bf16 v[192:207], v[56:59], v[136:139], v[192:207]
    ds_read_b128 v[156:159], v7 offset:24576
    v_add_f32 v213, 1.0, v213
    v_add_f32 v214, 1.0, v214
    v_add_f32 v215, 1.0, v215
    v_rcp_f32 v212, v212
    v_rcp_f32 v213, v213
    v_mfma_f32_32x32x16_bf16 v[192:207], v[60:63], v[140:143], v[192:207]
    v_rcp_f32 v214, v214
    v_rcp_f32 v215, v215
    v_mul_f32 v180, v180, v212
    v_mul_f32 v181, v181, v213
    v_mul_f32 v182, v182, v214
    s_waitcnt lgkmcnt(0)
    s_movk_i32 s63, 4096
    s_movk_i32 s64, 8192
    s_movk_i32 s65, 12288
    s_movk_i32 s66, 16384
    s_movk_i32 s67, 20480
    s_movk_i32 s68, 24576
    buffer_load_dwordx4 v[224:227], v3, s[44:47], 0 offen sc1
    buffer_load_dwordx4 v[228:231], v3, s[44:47], s63 offen sc1
    buffer_load_dwordx4 v[232:235], v3, s[44:47], s64 offen sc1
    buffer_load_dwordx4 v[236:239], v3, s[44:47], s65 offen sc1
    buffer_load_dwordx4 v[240:243], v3, s[44:47], s66 offen sc1
    buffer_load_dwordx4 v[244:247], v3, s[44:47], s67 offen sc1
    buffer_load_dwordx4 v[248:251], v3, s[44:47], s68 offen sc1
    v_mfma_f32_32x32x16_bf16 v[192:207], v[64:67], v[144:147], v[192:207]
    ds_read_b128 v[128:131], v4 offset:32768
    ds_read_b128 v[132:135], v5 offset:32768
    v_mul_f32 v183, v183, v215
    v_mul_f32 v208, v184, v184
    v_mul_f32 v209, v185, v185
    v_mul_f32 v210, v186, v186
    v_mul_f32 v211, v187, v187
    v_mfma_f32_32x32x16_bf16 v[192:207], v[68:71], v[148:151], v[192:207]
    ds_read_b128 v[136:139], v6 offset:32768
    v_fmaak_f32 v208, v255, v208, 0xc0135761
    v_fmaak_f32 v209, v255, v209, 0xc0135761
    v_fmaak_f32 v210, v255, v210, 0xc0135761
    v_fmaak_f32 v211, v255, v211, 0xc0135761
    v_mul_f32 v208, v208, v184
    v_mfma_f32_32x32x16_bf16 v[192:207], v[72:75], v[152:155], v[192:207]
    ds_read_b128 v[140:143], v7 offset:32768
    v_mul_f32 v209, v209, v185
    v_mul_f32 v210, v210, v186
    v_mul_f32 v211, v211, v187
    v_exp_f32 v208, v208
    v_exp_f32 v209, v209
    v_mfma_f32_32x32x16_bf16 v[192:207], v[76:79], v[156:159], v[192:207]
    v_exp_f32 v210, v210
    v_exp_f32 v211, v211
    v_add_f32 v208, 1.0, v208
    v_add_f32 v209, 1.0, v209
    s_waitcnt lgkmcnt(0)
    v_mfma_f32_32x32x16_bf16 v[192:207], v[80:83], v[128:131], v[192:207]
    ds_read_b128 v[144:147], v4 offset:40960
    ds_read_b128 v[148:151], v5 offset:40960
    v_add_f32 v210, 1.0, v210
    v_add_f32 v211, 1.0, v211
    v_rcp_f32 v208, v208
    v_rcp_f32 v209, v209
    v_mfma_f32_32x32x16_bf16 v[192:207], v[84:87], v[132:135], v[192:207]
    ds_read_b128 v[152:155], v6 offset:40960
    v_rcp_f32 v210, v210
    v_rcp_f32 v211, v211
    v_mul_f32 v184, v184, v208
    v_mul_f32 v185, v185, v209
    v_mfma_f32_32x32x16_bf16 v[192:207], v[88:91], v[136:139], v[192:207]
    ds_read_b128 v[156:159], v7 offset:40960
    v_mul_f32 v186, v186, v210
    v_mul_f32 v187, v187, v211
    v_mul_f32 v212, v188, v188
    v_mul_f32 v213, v189, v189
    v_mfma_f32_32x32x16_bf16 v[192:207], v[92:95], v[140:143], v[192:207]
    v_mul_f32 v214, v190, v190
    v_mul_f32 v215, v191, v191
    v_fmaak_f32 v212, v255, v212, 0xc0135761
    v_fmaak_f32 v213, v255, v213, 0xc0135761
    s_waitcnt lgkmcnt(0)
    v_mfma_f32_32x32x16_bf16 v[192:207], v[96:99], v[144:147], v[192:207]
    ds_read_b128 v[128:131], v4 offset:49152
    ds_read_b128 v[132:135], v5 offset:49152
    v_fmaak_f32 v214, v255, v214, 0xc0135761
    v_fmaak_f32 v215, v255, v215, 0xc0135761
    v_mul_f32 v212, v212, v188
    v_mul_f32 v213, v213, v189
    v_mfma_f32_32x32x16_bf16 v[192:207], v[100:103], v[148:151], v[192:207]
    ds_read_b128 v[136:139], v6 offset:49152
    v_mul_f32 v214, v214, v190
    v_mul_f32 v215, v215, v191
    v_exp_f32 v212, v212
    v_exp_f32 v213, v213
    v_mfma_f32_32x32x16_bf16 v[192:207], v[104:107], v[152:155], v[192:207]
    ds_read_b128 v[140:143], v7 offset:49152
    v_exp_f32 v214, v214
    v_exp_f32 v215, v215
    v_add_f32 v212, 1.0, v212
    v_add_f32 v213, 1.0, v213
    v_mfma_f32_32x32x16_bf16 v[192:207], v[108:111], v[156:159], v[192:207]
    v_add_f32 v214, 1.0, v214
    v_add_f32 v215, 1.0, v215
    v_rcp_f32 v212, v212
    v_rcp_f32 v213, v213
    s_waitcnt lgkmcnt(0)
    v_mfma_f32_32x32x16_bf16 v[192:207], v[112:115], v[128:131], v[192:207]
    v_rcp_f32 v214, v214
    v_rcp_f32 v215, v215
    v_mul_f32 v188, v188, v212
    v_mul_f32 v189, v189, v213
    v_mfma_f32_32x32x16_bf16 v[192:207], v[116:119], v[132:135], v[192:207]
    v_mul_f32 v190, v190, v214
    v_mul_f32 v191, v191, v215
    v_cvt_pk_bf16_f32 v216, v176, v177
    v_cvt_pk_bf16_f32 v217, v178, v179
    v_mfma_f32_32x32x16_bf16 v[192:207], v[120:123], v[136:139], v[192:207]
    v_cvt_pk_bf16_f32 v218, v180, v181
    v_cvt_pk_bf16_f32 v219, v182, v183
    buffer_store_dwordx4 v[216:219], v15, s[40:43], s77 offen offset:0 sc1
    v_cvt_pk_bf16_f32 v220, v184, v185
    v_mfma_f32_32x32x16_bf16 v[192:207], v[124:127], v[140:143], v[192:207]
    v_cvt_pk_bf16_f32 v221, v186, v187
    v_cvt_pk_bf16_f32 v222, v188, v189
    v_cvt_pk_bf16_f32 v223, v190, v191
    buffer_store_dwordx4 v[220:223], v15, s[40:43], s77 offen offset:512 sc1
    v_and_b32 v208, 15, v0
    v_bfe_u32 v209, v0, 4, 1
    v_lshlrev_b32 v208, 4, v208
    v_lshl_add_u32 v208, v209, 3, v208
    s_lshl_b32 s62, s54, 8
    s_add_u32 s62, s62, 122880
    v_add_u32 v208, s62, v208
    v_lshrrev_b32 v209, 5, v0
    v_lshlrev_b32 v209, 5, v209
    v_add_u32 v209, s62, v209

    s_waitcnt vmcnt(2)
L_k1re_8:
    v_min_f32 v210, v225, v227
    v_min3_f32 v210, v210, v229, v231
    v_min3_f32 v210, v210, v233, v235
    v_min3_f32 v210, v210, v237, v239
    v_min3_f32 v210, v210, v241, v243
    v_min3_f32 v210, v210, v245, v247
    v_min3_f32 v210, v210, v249, v251
    v_cmp_gt_f32 vcc, 0, v210
    s_nop 1
    s_cmp_eq_u64 vcc, 0
    s_cbranch_scc1 L_k1go_9
    s_sleep 4

    buffer_load_dwordx4 v[224:227], v3, s[44:47], 0 offen sc1
    buffer_load_dwordx4 v[228:231], v3, s[44:47], s63 offen sc1
    buffer_load_dwordx4 v[232:235], v3, s[44:47], s64 offen sc1
    buffer_load_dwordx4 v[236:239], v3, s[44:47], s65 offen sc1
    buffer_load_dwordx4 v[240:243], v3, s[44:47], s66 offen sc1
    buffer_load_dwordx4 v[244:247], v3, s[44:47], s67 offen sc1
    buffer_load_dwordx4 v[248:251], v3, s[44:47], s68 offen sc1
    s_sub_u32 s70, s70, 1
    s_cmp_gt_i32 s70, 0
    s_waitcnt vmcnt(0)
    s_cbranch_scc1 L_k1re_8

L_k1go_9:
    v_add_f32 v224, v224, v228
    v_add_f32 v225, v225, v229
    v_add_f32 v226, v226, v230
    v_add_f32 v227, v227, v231
    v_add_f32 v224, v224, v232
    v_add_f32 v225, v225, v233
    v_add_f32 v226, v226, v234
    v_add_f32 v227, v227, v235
    v_add_f32 v224, v224, v236
    v_add_f32 v225, v225, v237
    v_add_f32 v226, v226, v238
    v_add_f32 v227, v227, v239
    v_add_f32 v224, v224, v240
    v_add_f32 v225, v225, v241
    v_add_f32 v226, v226, v242
    v_add_f32 v227, v227, v243
    v_add_f32 v224, v224, v244
    v_add_f32 v225, v225, v245
    v_add_f32 v226, v226, v246
    v_add_f32 v227, v227, v247
    v_add_f32 v224, v224, v248
    v_add_f32 v225, v225, v249
    v_add_f32 v226, v226, v250
    v_add_f32 v227, v227, v251
    s_nop 0
    v_permlane16_swap_b32 v224, v226
    v_permlane16_swap_b32 v225, v227
    v_add_f32 v224, v224, v226
    v_add_f32 v225, v225, v227
    v_mov_b32 v226, v224
    v_mov_b32 v227, v225
    s_nop 0
    v_permlane32_swap_b32 v224, v226
    v_permlane32_swap_b32 v225, v227
    v_add_f32 v224, v224, v226
    v_add_f32 v225, v225, v227
    v_mul_f32 v224, 0x3a924925, v224
    v_mul_f32 v225, 0x3a924925, v225
    v_fma_f32 v225, -v224, v224, v225
    v_max_f32 v225, 0, v225
    v_add_f32 v225, 0x3727c5ac, v225
    v_rsq_f32 v226, v225
    s_nop 0
    v_mul_f32 v227, v224, v226
    v_xor_b32 v227, 0x80000000, v227
    ds_write_b64 v208, v[226:227]
    s_waitcnt lgkmcnt(0)

    ds_read_b128 v[48:51], v209 offset:0
    ds_read_b128 v[52:55], v209 offset:16
    ds_read_b128 v[56:59], v209 offset:64
    ds_read_b128 v[60:63], v209 offset:80
    ds_read_b128 v[64:67], v209 offset:128
    ds_read_b128 v[68:71], v209 offset:144
    ds_read_b128 v[72:75], v209 offset:192
    ds_read_b128 v[76:79], v209 offset:208
    v_cvt_pk_bf16_f32 v232, v192, v193
    v_cvt_pk_bf16_f32 v233, v194, v195
    v_cvt_pk_bf16_f32 v234, v200, v201
    v_cvt_pk_bf16_f32 v235, v202, v203
    buffer_store_dwordx4 v[232:235], v14, s[36:39], s76 offen offset:0 sc1
    v_cvt_pk_bf16_f32 v236, v196, v197
    v_cvt_pk_bf16_f32 v237, v198, v199
    v_cvt_pk_bf16_f32 v238, v204, v205
    v_cvt_pk_bf16_f32 v239, v206, v207
    buffer_store_dwordx4 v[236:239], v14, s[36:39], s76 offen offset:512 sc1
    s_waitcnt lgkmcnt(6)
    v_fma_f32 v160, v160, v48, v49
    v_fma_f32 v161, v161, v50, v51
    v_fma_f32 v162, v162, v52, v53
    v_fma_f32 v163, v163, v54, v55
    s_waitcnt lgkmcnt(2)
    v_fma_f32 v168, v168, v64, v65
    v_fma_f32 v169, v169, v66, v67
    v_fma_f32 v170, v170, v68, v69
    v_fma_f32 v171, v171, v70, v71
    s_waitcnt lgkmcnt(0)
    v_fma_f32 v164, v164, v56, v57
    v_fma_f32 v165, v165, v58, v59
    v_fma_f32 v166, v166, v60, v61
    v_fma_f32 v167, v167, v62, v63
    s_waitcnt lgkmcnt(0)
    v_fma_f32 v172, v172, v72, v73
    v_fma_f32 v173, v173, v74, v75
    v_fma_f32 v174, v174, v76, v77
    v_fma_f32 v175, v175, v78, v79
    v_cvt_pk_bf16_f32 v240, v160, v161
    v_cvt_pk_bf16_f32 v241, v162, v163
    v_cvt_pk_bf16_f32 v242, v168, v169
    v_cvt_pk_bf16_f32 v243, v170, v171
    buffer_store_dwordx4 v[240:243], v14, s[36:39], s75 offen offset:0 sc1
    v_cvt_pk_bf16_f32 v244, v164, v165
    v_cvt_pk_bf16_f32 v245, v166, v167
    v_cvt_pk_bf16_f32 v246, v172, v173
    v_cvt_pk_bf16_f32 v247, v174, v175
    buffer_store_dwordx4 v[244:247], v14, s[36:39], s75 offen offset:512 sc1
    v_mov_b32 v20, 0x01010101
    s_add_u32 s4, s22, 24182784
    s_addc_u32 s5, s23, 0
    s_mov_b32 s6, 32768
    s_mov_b32 s7, 0x20000
    s_lshl_b32 s62, s57, 4
    s_add_u32 s62, s62, s58
    s_lshl_b32 s62, s62, 7
    v_mov_b32 v22, 1
    v_mov_b32 v23, s62
    s_cmp_lg_u32 s54, 0
    s_waitcnt vmcnt(0)
    s_barrier
    s_cbranch_scc1 L_k2entry
    s_mov_b64 exec, 1
    buffer_store_dword v22, v23, s[4:7], 0 offen sc1
    s_mov_b64 exec, -1
    s_branch L_k2entry

L_k1help_2:
    s_lshl_b32 s55, s52, 2
    s_add_u32 s55, s55, s53
    s_sub_u32 s55, s55, 28
    s_waitcnt lgkmcnt(0)
    s_mov_b32 s24, s4
    s_mov_b32 s25, s5
    s_mov_b32 s26, 1835008
    s_mov_b32 s27, 0x20000
    s_mov_b32 s28, s18
    s_mov_b32 s29, s19
    s_mov_b32 s30, 896
    s_mov_b32 s31, 0x20000
    s_mov_b32 s32, s16
    s_mov_b32 s33, s17
    s_mov_b32 s34, 802816
    s_mov_b32 s35, 0x20000
    s_add_u32 s36, s22, 20971520
    s_addc_u32 s37, s23, 0
    s_mov_b32 s38, 802816
    s_mov_b32 s39, 0x20000
    s_add_u32 s40, s22, 22020096
    s_addc_u32 s41, s23, 0
    s_mov_b32 s42, 8192
    s_mov_b32 s43, 0x20000
    v_lshrrev_b32 v1, 3, v0
    s_lshl_b32 s56, s55, 6
    s_lshl_b32 s57, s54, 3
    s_add_u32 s56, s56, s57
    v_add_u32 v1, s56, v1
    v_and_b32 v2, 7, v0
    v_lshlrev_b32 v2, 4, v2
    v_mul_u32_u24 v3, 896, v1
    v_add_u32 v3, v3, v2

    s_mul_i32 s56, s55, 14336
    s_mul_i32 s57, s54, 1792
    s_add_u32 s56, s56, s57
    s_add_u32 s56, s56, 23068672
    s_add_u32 s44, s22, s56
    s_addc_u32 s45, s23, 0
    s_movk_i32 s46, 1792
    s_mov_b32 s47, 0x20000
    v_lshlrev_b32 v4, 4, v0
    v_mov_b32 v8, -1.0
    v_mov_b32 v9, -1.0
    v_mov_b32 v10, -1.0
    v_mov_b32 v11, -1.0
    buffer_store_dwordx4 v[8:11], v4, s[44:47], 0 offen sc1
    s_mov_b32 exec_hi, 0xffff
    buffer_store_dwordx4 v[8:11], v4, s[44:47], 0 offen offset:1024 sc1
    s_mov_b32 exec_hi, -1

    s_add_u32 s44, s22, 24182784
    s_addc_u32 s45, s23, 0
    s_mov_b32 s46, 32768
    s_lshl_b32 s56, s55, 3
    s_add_u32 s56, s56, s54
    s_lshl_b32 s56, s56, 7
    v_mov_b32 v12, 0
    v_mov_b32 v13, s56
    s_mov_b64 exec, 1
    buffer_store_dword v12, v13, s[44:47], 0 offen sc1
    s_mov_b64 exec, -1

    buffer_load_dwordx4 v[16:19], v3, s[24:27], 0 offen offset:0
    buffer_load_dwordx4 v[48:51], v2, s[28:31], 0 offen offset:0
    buffer_load_dwordx4 v[20:23], v3, s[24:27], 0 offen offset:128
    buffer_load_dwordx4 v[52:55], v2, s[28:31], 0 offen offset:128
    buffer_load_dwordx4 v[24:27], v3, s[24:27], 0 offen offset:256
    buffer_load_dwordx4 v[56:59], v2, s[28:31], 0 offen offset:256
    buffer_load_dwordx4 v[28:31], v3, s[24:27], 0 offen offset:384
    buffer_load_dwordx4 v[60:63], v2, s[28:31], 0 offen offset:384
    buffer_load_dwordx4 v[32:35], v3, s[24:27], 0 offen offset:512
    buffer_load_dwordx4 v[64:67], v2, s[28:31], 0 offen offset:512
    buffer_load_dwordx4 v[36:39], v3, s[24:27], 0 offen offset:640
    buffer_load_dwordx4 v[68:71], v2, s[28:31], 0 offen offset:640
    buffer_load_dwordx4 v[40:43], v3, s[24:27], 0 offen offset:768
    buffer_load_dwordx4 v[72:75], v2, s[28:31], 0 offen offset:768
    s_mov_b32 s48, s20
    s_mov_b32 s49, s21
    s_movk_i32 s50, 256
    s_mov_b32 s51, 0x20000
    v_mov_b32 v12, 1
    v_mov_b32 v13, s55
    s_waitcnt vmcnt(14)
    s_barrier
    s_cmp_lg_u32 s54, 0
    s_cbranch_scc1 L_k1hf_11
    s_mov_b64 exec, 1
    buffer_store_byte v12, v13, s[48:51], 0 offen sc1
    s_mov_b64 exec, -1

L_k1hf_11:
    s_cmp_lg_u32 s55, 31
    s_cbranch_scc1 L_k1hz_12
    s_add_u32 s48, s22, 24117248
    s_addc_u32 s49, s23, 0
    s_mov_b32 s50, 32768
    v_mov_b32 v14, 0
    v_mov_b32 v15, 0

    s_lshl_b32 s56, s54, 12
    v_lshlrev_b32 v13, 4, v0
    v_mov_b32 v200, 0
    v_mov_b32 v201, 0
    v_mov_b32 v202, 0
    v_mov_b32 v203, 0

    buffer_store_dwordx4 v[200:203], v13, s[48:51], s56 offen offset:0 sc1
    buffer_store_dwordx4 v[200:203], v13, s[48:51], s56 offen offset:1024 sc1
    buffer_store_dwordx4 v[200:203], v13, s[48:51], s56 offen offset:2048 sc1
    buffer_store_dwordx4 v[200:203], v13, s[48:51], s56 offen offset:3072 sc1
L_k1hz_12:
    s_cmp_ge_u32 s55, 28
    s_cbranch_scc1 L_k1gate_10
    s_mul_i32 s58, s55, 28672
    s_lshl_b32 s59, s54, 10
    s_add_u32 s58, s58, s59
    v_lshlrev_b32 v4, 4, v0

    s_add_u32 m0, s59, 0
    s_nop 0
    buffer_load_dwordx4 v4, s[32:35], s58 offen  lds
    s_add_u32 s58, s58, 8192

    s_add_u32 m0, s59, 8192
    s_nop 0
    buffer_load_dwordx4 v4, s[32:35], s58 offen  lds
    s_add_u32 s58, s58, 8192

    s_add_u32 m0, s59, 16384
    s_nop 0
    buffer_load_dwordx4 v4, s[32:35], s58 offen  lds
    s_add_u32 s58, s58, 8192

    s_cmp_ge_u32 s54, 4
    s_cbranch_scc1 L_k1h3_13
    s_add_u32 m0, s59, 24576
    s_nop 0
    buffer_load_dwordx4 v4, s[32:35], s58 offen  lds
    s_add_u32 s58, s58, 8192

L_k1h3_13:
    v_lshrrev_b32 v5, 2, v0
    v_mul_u32_u24 v5, 896, v5
    v_and_b32 v6, 3, v0
    v_lshl_add_u32 v5, v6, 4, v5
    s_lshr_b32 s60, s54, 1
    s_lshl_b32 s60, s60, 6
    s_and_b32 s61, s54, 1
    s_lshl_b32 s61, s61, 3
    s_add_u32 s60, s60, s61
    v_add_u32 v5, s60, v5
    s_mul_i32 s60, s54, 28
    s_add_u32 s60, s60, s55
    s_lshl_b32 s60, s60, 10
    s_waitcnt vmcnt(0)
    s_barrier

    ds_read_b64_tr_b16 v[80:81], v5 offset:0
    ds_read_b64_tr_b16 v[82:83], v5 offset:14336
    ds_read_b64_tr_b16 v[84:85], v5 offset:256
    ds_read_b64_tr_b16 v[86:87], v5 offset:14592
    ds_read_b64_tr_b16 v[88:89], v5 offset:512
    ds_read_b64_tr_b16 v[90:91], v5 offset:14848
    ds_read_b64_tr_b16 v[92:93], v5 offset:768
    ds_read_b64_tr_b16 v[94:95], v5 offset:15104
    s_waitcnt lgkmcnt(6)
    buffer_store_dwordx4 v[80:83], v4, s[36:39], s60 offen sc1
    s_add_u32 s60, s60, 229376
    s_waitcnt lgkmcnt(4)
    buffer_store_dwordx4 v[84:87], v4, s[36:39], s60 offen sc1
    s_add_u32 s60, s60, 229376
    s_waitcnt lgkmcnt(2)
    buffer_store_dwordx4 v[88:91], v4, s[36:39], s60 offen sc1
    s_add_u32 s60, s60, 229376
    s_waitcnt lgkmcnt(0)
    s_cmp_ge_u32 s54, 4
    s_cbranch_scc1 L_k1gate_10
    buffer_store_dwordx4 v[92:95], v4, s[36:39], s60 offen sc1
    s_add_u32 s60, s60, 229376
L_k1gate_10:
    s_waitcnt vmcnt(0)
    v_mov_b32 v8, 0
    v_mov_b32 v9, 0
    v_dot2c_f32_bf16 v8, v16, v48
    v_dot2c_f32_bf16 v9, v17, v49
    v_dot2c_f32_bf16 v8, v18, v50
    v_dot2c_f32_bf16 v9, v19, v51
    v_dot2c_f32_bf16 v8, v20, v52
    v_dot2c_f32_bf16 v9, v21, v53
    v_dot2c_f32_bf16 v8, v22, v54
    v_dot2c_f32_bf16 v9, v23, v55
    v_dot2c_f32_bf16 v8, v24, v56
    v_dot2c_f32_bf16 v9, v25, v57
    v_dot2c_f32_bf16 v8, v26, v58
    v_dot2c_f32_bf16 v9, v27, v59
    v_dot2c_f32_bf16 v8, v28, v60
    v_dot2c_f32_bf16 v9, v29, v61
    v_dot2c_f32_bf16 v8, v30, v62
    v_dot2c_f32_bf16 v9, v31, v63
    v_dot2c_f32_bf16 v8, v32, v64
    v_dot2c_f32_bf16 v9, v33, v65
    v_dot2c_f32_bf16 v8, v34, v66
    v_dot2c_f32_bf16 v9, v35, v67
    v_dot2c_f32_bf16 v8, v36, v68
    v_dot2c_f32_bf16 v9, v37, v69
    v_dot2c_f32_bf16 v8, v38, v70
    v_dot2c_f32_bf16 v9, v39, v71
    v_dot2c_f32_bf16 v8, v40, v72
    v_dot2c_f32_bf16 v9, v41, v73
    v_dot2c_f32_bf16 v8, v42, v74
    v_dot2c_f32_bf16 v9, v43, v75
    s_nop 2
    v_add_f32 v8, v8, v9
    s_nop 1
    v_add_f32_dpp v8, v8, v8 quad_perm:[1,0,3,2] row_mask:0xf bank_mask:0xf
    s_nop 1
    v_add_f32_dpp v8, v8, v8 quad_perm:[2,3,0,1] row_mask:0xf bank_mask:0xf
    s_nop 1
    v_add_f32_dpp v8, v8, v8 row_half_mirror row_mask:0xf bank_mask:0xf
    v_mul_f32 v8, 0xbfb8aa3b, v8
    v_exp_f32 v8, v8
    s_nop 0
    v_add_f32 v8, 1.0, v8
    v_rcp_f32 v8, v8
    v_lshlrev_b32 v1, 2, v1
    buffer_store_dword v8, v1, s[40:43], 0 offen sc1

    s_load_dwordx4 s[4:7], s[0:1], 8
    s_load_dwordx2 s[8:9], s[0:1], 56

    s_waitcnt lgkmcnt(0)
    s_lshl_b32 s62, s53, 3
    s_add_u32 s62, s62, s54
    s_mov_b32 s10, 0x800000
    s_mov_b32 s11, 0x20000
    s_cmp_ge_u32 s52, 4
    s_cbranch_scc1 L_k1pr1_14
    s_lshl_b32 s62, s62, 13
    s_lshl_b32 s63, s52, 21
    s_add_u32 s62, s62, s63
    v_and_b32 v253, 31, v0
    v_min_u32 v253, 7, v253

    v_lshrrev_b32 v1, 5, v0
    v_lshlrev_b32 v1, 12, v1
    v_lshl_add_u32 v1, v253, 7, v1
    buffer_load_dword v254, v1, s[8:11], s62 offen offset:0
    s_branch L_k1pe_15

L_k1pr1_14:
    s_bitcmp1_b32 s52, 1
    s_cselect_b32 s4, s6, s4
    s_cselect_b32 s5, s7, s5
    s_cmp_ge_u32 s52, 4
    s_cselect_b32 s8, s4, s8
    s_cselect_b32 s9, s5, s9
    s_lshl_b32 s62, s62, 14
    s_and_b32 s63, s52, 1
    s_lshl_b32 s63, s63, 22
    s_add_u32 s62, s62, s63
    v_and_b32 v253, 15, v0
    v_min_u32 v253, 7, v253

    v_lshrrev_b32 v1, 4, v0
    v_lshlrev_b32 v1, 12, v1
    v_lshl_add_u32 v1, v253, 7, v1
    buffer_load_dword v254, v1, s[8:11], s62 offen offset:0

L_k1pe_15:
    s_add_u32 s48, s22, 12582912
    s_addc_u32 s49, s23, 0
    s_mov_b32 s50, 7864320
    s_mov_b32 s51, 0x20000
    s_lshl_b32 s56, s55, 3
    s_add_u32 s56, s56, s54
    s_mul_i32 s56, s56, 14336
    v_lshlrev_b32 v13, 4, v0
    v_add_u32 v13, s56, v13
    v_mov_b32 v200, -1
    v_mov_b32 v201, -1
    v_mov_b32 v202, -1
    v_mov_b32 v203, -1

    buffer_store_dwordx4 v[200:203], v13, s[48:51], 0 offen offset:0 sc1
    buffer_store_dwordx4 v[200:203], v13, s[48:51], 0 offen offset:1024 sc1
    buffer_store_dwordx4 v[200:203], v13, s[48:51], 0 offen offset:2048 sc1
    buffer_store_dwordx4 v[200:203], v13, s[48:51], 0 offen offset:3072 sc1
    v_add_u32 v13, 0x1000, v13
    buffer_store_dwordx4 v[200:203], v13, s[48:51], 0 offen offset:0 sc1
    buffer_store_dwordx4 v[200:203], v13, s[48:51], 0 offen offset:1024 sc1
    buffer_store_dwordx4 v[200:203], v13, s[48:51], 0 offen offset:2048 sc1
    buffer_store_dwordx4 v[200:203], v13, s[48:51], 0 offen offset:3072 sc1
    v_add_u32 v13, 0x1000, v13
    buffer_store_dwordx4 v[200:203], v13, s[48:51], 0 offen offset:0 sc1
    buffer_store_dwordx4 v[200:203], v13, s[48:51], 0 offen offset:1024 sc1
    buffer_store_dwordx4 v[200:203], v13, s[48:51], 0 offen offset:2048 sc1
    buffer_store_dwordx4 v[200:203], v13, s[48:51], 0 offen offset:3072 sc1
    v_add_u32 v13, 0x1000, v13
    buffer_store_dwordx4 v[200:203], v13, s[48:51], 0 offen offset:0 sc1
    buffer_store_dwordx4 v[200:203], v13, s[48:51], 0 offen offset:1024 sc1
    s_cmp_lg_u32 s54, 4
    s_cbranch_scc1 L_k1dl_16
    s_mov_b32 s48, s20
    s_mov_b32 s49, s21
    s_movk_i32 s50, 256
    s_mov_b32 s51, 0x20000
    v_min_u32 v21, 7, v0
    v_lshlrev_b32 v21, 2, v21
    v_add_u32 v21, 128, v21
    buffer_load_dword v20, v21, s[48:51], 0 offen sc1

L_k1dl_16:
    s_mov_b32 s62, -1
    s_mov_b32 s48, s20
    s_mov_b32 s49, s21
    s_movk_i32 s50, 256
    s_mov_b32 s51, 0x20000
    s_add_u32 s56, s55, 128
    v_mov_b32 v22, 1
    v_mov_b32 v23, s56
    s_cmp_lg_u32 s54, 0
    s_waitcnt vmcnt(0)
    s_barrier
    s_cbranch_scc1 L_k2entry
    s_mov_b64 exec, 1
    buffer_store_byte v22, v23, s[48:51], 0 offen sc1
    s_mov_b64 exec, -1
    s_branch L_k2entry

L_k1end_1:
    s_endpgm
L_k2entry:
    s_mov_b32 s40, s54

    s_load_dwordx4 s[4:7], s[0:1], 8
    s_load_dwordx4 s[28:31], s[0:1], 56
    s_load_dwordx2 s[32:33], s[0:1], 104
    s_and_b32 s34, s2, 7
    s_lshr_b32 s35, s2, 3
    s_and_b32 s36, s34, 3
    s_lshl_b32 s36, s36, 2
    s_lshr_b32 s37, s35, 3
    s_add_u32 s36, s36, s37
    s_and_b32 s37, s35, 7
    s_lshr_b32 s38, s34, 2

    s_and_b32 s41, s34, 1
    s_lshl_b32 s41, s41, 3
    s_lshr_b32 s42, s35, 2
    s_add_u32 s41, s41, s42
    s_and_b32 s42, s34, 2
    s_lshl_b32 s42, s42, 1
    s_and_b32 s43, s35, 3
    s_add_u32 s42, s42, s43
    s_cmp_lg_u32 s38, 0
    s_cselect_b32 s36, s41, s36
    s_cselect_b32 s37, s42, s37

    s_lshl_b32 s39, s38, 3
    s_add_u32 s39, s39, s37

    s_waitcnt lgkmcnt(0)
    s_cmp_lt_u32 s37, 4
    s_cselect_b32 s4, s4, s6
    s_cselect_b32 s5, s5, s7
    s_cmp_eq_u32 s38, 0
    s_cselect_b32 s4, s28, s4
    s_cselect_b32 s5, s29, s5
    s_lshl_b32 s41, s36, 19
    s_add_u32 s8, s4, s41
    s_addc_u32 s9, s5, 0
    s_mov_b32 s10, 0x80000
    s_mov_b32 s11, 0x20000
    s_mul_i32 s41, s39, 458752
    s_add_u32 s12, s32, s41
    s_addc_u32 s13, s33, 0
    s_mov_b32 s14, 458752
    s_mov_b32 s15, 0x20000
    s_cmp_ge_u32 s40, 4
    s_cbranch_scc1 L_k2load_18

    s_lshr_b32 s42, s40, 1
    s_and_b32 s43, s40, 1
    v_and_b32 v1, 15, v0
    v_lshrrev_b32 v5, 4, v0
    s_lshl_b32 s44, s43, 2
    v_add_u32 v5, s44, v5
    v_lshrrev_b32 v6, 1, v1
    v_xor_b32 v5, v5, v6
    v_lshlrev_b32 v5, 4, v5
    v_lshl_add_u32 v5, v1, 7, v5
    s_lshl_b32 s44, s42, 13
    s_lshl_b32 s45, s43, 12
    s_add_u32 s46, s44, s45
    s_xor_b32 s47, s46, 0x1000
    v_add_u32 v2, s46, v5
    v_add_u32 v3, s47, v5
    s_mul_i32 s44, s43, 7168
    s_add_u32 s44, s44, 16384
    v_lshlrev_b32 v126, 4, v0
    v_add_u32 v4, s44, v126

    s_lshl_b32 s44, s36, 3
    s_lshl_b32 s45, s42, 2
    s_add_u32 s44, s44, s45
    s_lshl_b32 s45, s43, 1
    s_add_u32 s44, s44, s45
    s_mul_i32 s45, s37, 7
    s_add_u32 s45, s45, 1
    s_lshr_b32 s45, s45, 1
    s_mul_i32 s46, s44, 28
    s_add_u32 s46, s46, s45
    s_lshl_b32 s48, s46, 10
    s_add_u32 s49, s48, 28672
    s_and_b32 s47, s37, 1
    s_movk_i32 s46, 3072
    s_cmp_eq_u32 s47, 0
    s_cselect_b32 s47, s46, -1016
    s_add_u32 s50, s48, s47
    s_add_u32 s51, s49, s47
    s_add_u32 s16, s32, 8388608
    s_addc_u32 s17, s33, 0
    s_mov_b32 s18, 3670016
    s_mov_b32 s19, 0x20000
    s_mov_b32 s46, 12582912
    s_cmp_eq_u32 s38, 0
    s_cselect_b32 s47, s46, 16777216
    s_add_u32 s20, s32, s47
    s_addc_u32 s21, s33, 0
    s_mov_b32 s22, 3670016
    s_mov_b32 s23, 0x20000
    s_mov_b32 s24, s30
    s_mov_b32 s25, s31
    s_mov_b32 s26, 4096
    s_mov_b32 s27, 0x20000

    v_lshrrev_b32 v5, 2, v1
    v_lshlrev_b32 v5, 3, v5
    v_and_b32 v6, 3, v1
    v_add_u32 v5, v5, v6
    s_lshl_b32 s47, s44, 4
    v_add_u32 v5, s47, v5
    v_lshlrev_b32 v129, 1, v5
    s_cmp_lg_u32 s38, 0
    s_cselect_b32 s67, 0, 3

    v_mov_b32 v144, 0
    v_mov_b32 v145, 0
    v_mov_b32 v146, 0
    v_mov_b32 v147, 0
    v_mov_b32 v148, 0
    v_mov_b32 v149, 0
    v_mov_b32 v150, 0
    v_mov_b32 v151, 0
    v_mov_b32 v152, 0
    v_mov_b32 v153, 0
    v_mov_b32 v154, 0
    v_mov_b32 v155, 0
    v_mov_b32 v156, 0
    v_mov_b32 v157, 0
    v_mov_b32 v158, 0
    v_mov_b32 v159, 0
    v_mov_b32 v160, 0
    v_mov_b32 v161, 0
    v_mov_b32 v162, 0
    v_mov_b32 v163, 0
    v_mov_b32 v164, 0
    v_mov_b32 v165, 0
    v_mov_b32 v166, 0
    v_mov_b32 v167, 0
    v_mov_b32 v168, 0
    v_mov_b32 v169, 0
    v_mov_b32 v170, 0
    v_mov_b32 v171, 0
    v_mov_b32 v172, 0
    v_mov_b32 v173, 0
    v_mov_b32 v174, 0
    v_mov_b32 v175, 0
    v_mov_b32 v176, 0
    v_mov_b32 v177, 0
    v_mov_b32 v178, 0
    v_mov_b32 v179, 0
    v_mov_b32 v180, 0
    v_mov_b32 v181, 0
    v_mov_b32 v182, 0
    v_mov_b32 v183, 0
    v_mov_b32 v184, 0
    v_mov_b32 v185, 0
    v_mov_b32 v186, 0
    v_mov_b32 v187, 0
    v_mov_b32 v188, 0
    v_mov_b32 v189, 0
    v_mov_b32 v190, 0
    v_mov_b32 v191, 0
    v_mov_b32 v192, 0
    v_mov_b32 v193, 0
    v_mov_b32 v194, 0
    v_mov_b32 v195, 0
    v_mov_b32 v196, 0
    v_mov_b32 v197, 0
    v_mov_b32 v198, 0
    v_mov_b32 v199, 0
    v_mov_b32 v200, 0
    v_mov_b32 v201, 0
    v_mov_b32 v202, 0
    v_mov_b32 v203, 0
    v_mov_b32 v204, 0
    v_mov_b32 v205, 0
    v_mov_b32 v206, 0
    v_mov_b32 v207, 0
    v_mov_b32 v208, 0
    v_mov_b32 v209, 0
    v_mov_b32 v210, 0
    v_mov_b32 v211, 0
    v_mov_b32 v212, 0
    v_mov_b32 v213, 0
    v_mov_b32 v214, 0
    v_mov_b32 v215, 0
    v_mov_b32 v216, 0
    v_mov_b32 v217, 0
    v_mov_b32 v218, 0
    v_mov_b32 v219, 0
    v_mov_b32 v220, 0
    v_mov_b32 v221, 0
    v_mov_b32 v222, 0
    v_mov_b32 v223, 0
    v_mov_b32 v224, 0
    v_mov_b32 v225, 0
    v_mov_b32 v226, 0
    v_mov_b32 v227, 0
    v_mov_b32 v228, 0
    v_mov_b32 v229, 0
    v_mov_b32 v230, 0
    v_mov_b32 v231, 0
    v_mov_b32 v232, 0
    v_mov_b32 v233, 0
    v_mov_b32 v234, 0
    v_mov_b32 v235, 0
    v_mov_b32 v236, 0
    v_mov_b32 v237, 0
    v_mov_b32 v238, 0
    v_mov_b32 v239, 0
    v_mov_b32 v240, 0
    v_mov_b32 v241, 0
    v_mov_b32 v242, 0
    v_mov_b32 v243, 0
    v_mov_b32 v244, 0
    v_mov_b32 v245, 0
    v_mov_b32 v246, 0
    v_mov_b32 v247, 0
    v_mov_b32 v248, 0
    v_mov_b32 v249, 0
    v_mov_b32 v250, 0
    v_mov_b32 v251, 0
    v_mov_b32 v252, 0
    v_mov_b32 v253, 0
    v_mov_b32 v254, 0
    v_mov_b32 v255, 0
    s_mov_b32 s52, 0
    s_barrier
    s_barrier
    v_add_u32 v5, s52, v2
    v_add_u32 v6, s52, v3
    v_add_u32 v7, s52, v4
    s_add_u32 s52, s52, 30720
    s_cmp_eq_u32 s52, 153600
    s_cselect_b32 s52, 0, s52

    ds_read_b128 v[8:11], v5 offset:0
    ds_read_b128 v[40:43], v7 offset:0
    ds_read_b128 v[12:15], v5 offset:2048
    ds_read_b128 v[16:19], v6 offset:0
    ds_read_b128 v[20:23], v6 offset:2048
    ds_read_b128 v[44:47], v7 offset:1024
    ds_read_b128 v[48:51], v7 offset:2048
    ds_read_b128 v[52:55], v7 offset:3072
    ds_read_b128 v[56:59], v7 offset:4096
    ds_read_b128 v[60:63], v7 offset:5120
    ds_read_b128 v[64:67], v7 offset:6144
    s_waitcnt lgkmcnt(0)
    s_mov_b32 s53, 15
L_k2loop_20:
    s_barrier
    v_add_u32 v5, s52, v2
    v_add_u32 v6, s52, v3
    v_add_u32 v7, s52, v4
    s_add_u32 s52, s52, 30720
    s_cmp_eq_u32 s52, 153600
    s_cselect_b32 s52, 0, s52

    v_mfma_f32_16x16x32_bf16 v[144:147], v[40:43], v[8:11], v[144:147]
    ds_read_b128 v[24:27], v5 offset:0
    v_mfma_f32_16x16x32_bf16 v[148:151], v[40:43], v[12:15], v[148:151]
    v_mfma_f32_16x16x32_bf16 v[152:155], v[40:43], v[16:19], v[152:155]
    ds_read_b128 v[68:71], v7 offset:0
    v_mfma_f32_16x16x32_bf16 v[156:159], v[40:43], v[20:23], v[156:159]
    v_mfma_f32_16x16x32_bf16 v[160:163], v[44:47], v[8:11], v[160:163]
    ds_read_b128 v[28:31], v5 offset:2048
    v_mfma_f32_16x16x32_bf16 v[164:167], v[44:47], v[12:15], v[164:167]
    v_mfma_f32_16x16x32_bf16 v[168:171], v[44:47], v[16:19], v[168:171]
    ds_read_b128 v[32:35], v6 offset:0
    v_mfma_f32_16x16x32_bf16 v[172:175], v[44:47], v[20:23], v[172:175]
    v_mfma_f32_16x16x32_bf16 v[176:179], v[48:51], v[8:11], v[176:179]
    ds_read_b128 v[36:39], v6 offset:2048
    v_mfma_f32_16x16x32_bf16 v[180:183], v[48:51], v[12:15], v[180:183]
    v_mfma_f32_16x16x32_bf16 v[184:187], v[48:51], v[16:19], v[184:187]
    ds_read_b128 v[72:75], v7 offset:1024
    v_mfma_f32_16x16x32_bf16 v[188:191], v[48:51], v[20:23], v[188:191]
    v_mfma_f32_16x16x32_bf16 v[192:195], v[52:55], v[8:11], v[192:195]
    ds_read_b128 v[76:79], v7 offset:2048
    v_mfma_f32_16x16x32_bf16 v[196:199], v[52:55], v[12:15], v[196:199]
    v_mfma_f32_16x16x32_bf16 v[200:203], v[52:55], v[16:19], v[200:203]
    ds_read_b128 v[80:83], v7 offset:3072
    v_mfma_f32_16x16x32_bf16 v[204:207], v[52:55], v[20:23], v[204:207]
    v_mfma_f32_16x16x32_bf16 v[208:211], v[56:59], v[8:11], v[208:211]
    ds_read_b128 v[84:87], v7 offset:4096
    v_mfma_f32_16x16x32_bf16 v[212:215], v[56:59], v[12:15], v[212:215]
    v_mfma_f32_16x16x32_bf16 v[216:219], v[56:59], v[16:19], v[216:219]
    ds_read_b128 v[88:91], v7 offset:5120
    v_mfma_f32_16x16x32_bf16 v[220:223], v[56:59], v[20:23], v[220:223]
    v_mfma_f32_16x16x32_bf16 v[224:227], v[60:63], v[8:11], v[224:227]
    ds_read_b128 v[92:95], v7 offset:6144
    v_mfma_f32_16x16x32_bf16 v[228:231], v[60:63], v[12:15], v[228:231]
    v_mfma_f32_16x16x32_bf16 v[232:235], v[60:63], v[16:19], v[232:235]
    v_mfma_f32_16x16x32_bf16 v[236:239], v[60:63], v[20:23], v[236:239]
    v_mfma_f32_16x16x32_bf16 v[240:243], v[64:67], v[8:11], v[240:243]
    v_mfma_f32_16x16x32_bf16 v[244:247], v[64:67], v[12:15], v[244:247]
    v_mfma_f32_16x16x32_bf16 v[248:251], v[64:67], v[16:19], v[248:251]
    v_mfma_f32_16x16x32_bf16 v[252:255], v[64:67], v[20:23], v[252:255]
    s_waitcnt lgkmcnt(0)
    s_cmp_lg_u32 s53, s67
    s_cbranch_scc1 L_k2noz_19
    buffer_load_ushort v124, v129, s[24:27], 0 offen
    buffer_load_ushort v125, v129, s[24:27], 0 offen offset:8

    buffer_load_dwordx4 v[96:99], v126, s[16:19], s48 offen offset:0
    buffer_load_dwordx4 v[100:103], v126, s[16:19], s48 offen offset:1024
    buffer_load_dwordx4 v[104:107], v126, s[16:19], s48 offen offset:2048
    buffer_load_dwordx2 v[108:109], v126, s[16:19], s50 offen
    buffer_load_dwordx4 v[110:113], v126, s[16:19], s49 offen offset:0
    buffer_load_dwordx4 v[114:117], v126, s[16:19], s49 offen offset:1024
    buffer_load_dwordx4 v[118:121], v126, s[16:19], s49 offen offset:2048
    buffer_load_dwordx2 v[122:123], v126, s[16:19], s51 offen
L_k2noz_19:
    s_barrier
    v_add_u32 v5, s52, v2
    v_add_u32 v6, s52, v3
    v_add_u32 v7, s52, v4
    s_add_u32 s52, s52, 30720
    s_cmp_eq_u32 s52, 153600
    s_cselect_b32 s52, 0, s52

    v_mfma_f32_16x16x32_bf16 v[144:147], v[68:71], v[24:27], v[144:147]
    ds_read_b128 v[8:11], v5 offset:0
    v_mfma_f32_16x16x32_bf16 v[148:151], v[68:71], v[28:31], v[148:151]
    v_mfma_f32_16x16x32_bf16 v[152:155], v[68:71], v[32:35], v[152:155]
    ds_read_b128 v[40:43], v7 offset:0
    v_mfma_f32_16x16x32_bf16 v[156:159], v[68:71], v[36:39], v[156:159]
    v_mfma_f32_16x16x32_bf16 v[160:163], v[72:75], v[24:27], v[160:163]
    ds_read_b128 v[12:15], v5 offset:2048
    v_mfma_f32_16x16x32_bf16 v[164:167], v[72:75], v[28:31], v[164:167]
    v_mfma_f32_16x16x32_bf16 v[168:171], v[72:75], v[32:35], v[168:171]
    ds_read_b128 v[16:19], v6 offset:0
    v_mfma_f32_16x16x32_bf16 v[172:175], v[72:75], v[36:39], v[172:175]
    v_mfma_f32_16x16x32_bf16 v[176:179], v[76:79], v[24:27], v[176:179]
    ds_read_b128 v[20:23], v6 offset:2048
    v_mfma_f32_16x16x32_bf16 v[180:183], v[76:79], v[28:31], v[180:183]
    v_mfma_f32_16x16x32_bf16 v[184:187], v[76:79], v[32:35], v[184:187]
    ds_read_b128 v[44:47], v7 offset:1024
    v_mfma_f32_16x16x32_bf16 v[188:191], v[76:79], v[36:39], v[188:191]
    v_mfma_f32_16x16x32_bf16 v[192:195], v[80:83], v[24:27], v[192:195]
    ds_read_b128 v[48:51], v7 offset:2048
    v_mfma_f32_16x16x32_bf16 v[196:199], v[80:83], v[28:31], v[196:199]
    v_mfma_f32_16x16x32_bf16 v[200:203], v[80:83], v[32:35], v[200:203]
    ds_read_b128 v[52:55], v7 offset:3072
    v_mfma_f32_16x16x32_bf16 v[204:207], v[80:83], v[36:39], v[204:207]
    v_mfma_f32_16x16x32_bf16 v[208:211], v[84:87], v[24:27], v[208:211]
    ds_read_b128 v[56:59], v7 offset:4096
    v_mfma_f32_16x16x32_bf16 v[212:215], v[84:87], v[28:31], v[212:215]
    v_mfma_f32_16x16x32_bf16 v[216:219], v[84:87], v[32:35], v[216:219]
    ds_read_b128 v[60:63], v7 offset:5120
    v_mfma_f32_16x16x32_bf16 v[220:223], v[84:87], v[36:39], v[220:223]
    v_mfma_f32_16x16x32_bf16 v[224:227], v[88:91], v[24:27], v[224:227]
    ds_read_b128 v[64:67], v7 offset:6144
    v_mfma_f32_16x16x32_bf16 v[228:231], v[88:91], v[28:31], v[228:231]
    v_mfma_f32_16x16x32_bf16 v[232:235], v[88:91], v[32:35], v[232:235]
    v_mfma_f32_16x16x32_bf16 v[236:239], v[88:91], v[36:39], v[236:239]
    v_mfma_f32_16x16x32_bf16 v[240:243], v[92:95], v[24:27], v[240:243]
    v_mfma_f32_16x16x32_bf16 v[244:247], v[92:95], v[28:31], v[244:247]
    v_mfma_f32_16x16x32_bf16 v[248:251], v[92:95], v[32:35], v[248:251]
    v_mfma_f32_16x16x32_bf16 v[252:255], v[92:95], v[36:39], v[252:255]
    s_waitcnt lgkmcnt(0)
    s_sub_u32 s53, s53, 1
    s_cmp_lg_u32 s53, 0
    s_cbranch_scc1 L_k2loop_20

    s_barrier
    v_add_u32 v5, s52, v2
    v_add_u32 v6, s52, v3
    v_add_u32 v7, s52, v4
    s_add_u32 s52, s52, 30720
    s_cmp_eq_u32 s52, 153600
    s_cselect_b32 s52, 0, s52

    v_mfma_f32_16x16x32_bf16 v[144:147], v[40:43], v[8:11], v[144:147]
    ds_read_b128 v[24:27], v5 offset:0
    v_mfma_f32_16x16x32_bf16 v[148:151], v[40:43], v[12:15], v[148:151]
    v_mfma_f32_16x16x32_bf16 v[152:155], v[40:43], v[16:19], v[152:155]
    ds_read_b128 v[68:71], v7 offset:0
    v_mfma_f32_16x16x32_bf16 v[156:159], v[40:43], v[20:23], v[156:159]
    v_mfma_f32_16x16x32_bf16 v[160:163], v[44:47], v[8:11], v[160:163]
    ds_read_b128 v[28:31], v5 offset:2048
    v_mfma_f32_16x16x32_bf16 v[164:167], v[44:47], v[12:15], v[164:167]
    v_mfma_f32_16x16x32_bf16 v[168:171], v[44:47], v[16:19], v[168:171]
    ds_read_b128 v[32:35], v6 offset:0
    v_mfma_f32_16x16x32_bf16 v[172:175], v[44:47], v[20:23], v[172:175]
    v_mfma_f32_16x16x32_bf16 v[176:179], v[48:51], v[8:11], v[176:179]
    ds_read_b128 v[36:39], v6 offset:2048
    v_mfma_f32_16x16x32_bf16 v[180:183], v[48:51], v[12:15], v[180:183]
    v_mfma_f32_16x16x32_bf16 v[184:187], v[48:51], v[16:19], v[184:187]
    ds_read_b128 v[72:75], v7 offset:1024
    v_mfma_f32_16x16x32_bf16 v[188:191], v[48:51], v[20:23], v[188:191]
    v_mfma_f32_16x16x32_bf16 v[192:195], v[52:55], v[8:11], v[192:195]
    ds_read_b128 v[76:79], v7 offset:2048
    v_mfma_f32_16x16x32_bf16 v[196:199], v[52:55], v[12:15], v[196:199]
    v_mfma_f32_16x16x32_bf16 v[200:203], v[52:55], v[16:19], v[200:203]
    ds_read_b128 v[80:83], v7 offset:3072
    v_mfma_f32_16x16x32_bf16 v[204:207], v[52:55], v[20:23], v[204:207]
    v_mfma_f32_16x16x32_bf16 v[208:211], v[56:59], v[8:11], v[208:211]
    ds_read_b128 v[84:87], v7 offset:4096
    v_mfma_f32_16x16x32_bf16 v[212:215], v[56:59], v[12:15], v[212:215]
    v_mfma_f32_16x16x32_bf16 v[216:219], v[56:59], v[16:19], v[216:219]
    ds_read_b128 v[88:91], v7 offset:5120
    v_mfma_f32_16x16x32_bf16 v[220:223], v[56:59], v[20:23], v[220:223]
    v_mfma_f32_16x16x32_bf16 v[224:227], v[60:63], v[8:11], v[224:227]
    ds_read_b128 v[92:95], v7 offset:6144
    v_mfma_f32_16x16x32_bf16 v[228:231], v[60:63], v[12:15], v[228:231]
    v_mfma_f32_16x16x32_bf16 v[232:235], v[60:63], v[16:19], v[232:235]
    v_mfma_f32_16x16x32_bf16 v[236:239], v[60:63], v[20:23], v[236:239]
    v_mfma_f32_16x16x32_bf16 v[240:243], v[64:67], v[8:11], v[240:243]
    v_mfma_f32_16x16x32_bf16 v[244:247], v[64:67], v[12:15], v[244:247]
    v_mfma_f32_16x16x32_bf16 v[248:251], v[64:67], v[16:19], v[248:251]
    v_mfma_f32_16x16x32_bf16 v[252:255], v[64:67], v[20:23], v[252:255]
    s_waitcnt lgkmcnt(0)
    v_mfma_f32_16x16x32_bf16 v[144:147], v[68:71], v[24:27], v[144:147]
    v_mfma_f32_16x16x32_bf16 v[148:151], v[68:71], v[28:31], v[148:151]
    v_mfma_f32_16x16x32_bf16 v[152:155], v[68:71], v[32:35], v[152:155]
    v_mfma_f32_16x16x32_bf16 v[156:159], v[68:71], v[36:39], v[156:159]
    v_mfma_f32_16x16x32_bf16 v[160:163], v[72:75], v[24:27], v[160:163]
    v_mfma_f32_16x16x32_bf16 v[164:167], v[72:75], v[28:31], v[164:167]
    v_mfma_f32_16x16x32_bf16 v[168:171], v[72:75], v[32:35], v[168:171]
    v_mfma_f32_16x16x32_bf16 v[172:175], v[72:75], v[36:39], v[172:175]
    v_mfma_f32_16x16x32_bf16 v[176:179], v[76:79], v[24:27], v[176:179]
    v_mfma_f32_16x16x32_bf16 v[180:183], v[76:79], v[28:31], v[180:183]
    v_mfma_f32_16x16x32_bf16 v[184:187], v[76:79], v[32:35], v[184:187]
    v_mfma_f32_16x16x32_bf16 v[188:191], v[76:79], v[36:39], v[188:191]
    v_mfma_f32_16x16x32_bf16 v[192:195], v[80:83], v[24:27], v[192:195]
    v_mfma_f32_16x16x32_bf16 v[196:199], v[80:83], v[28:31], v[196:199]
    v_mfma_f32_16x16x32_bf16 v[200:203], v[80:83], v[32:35], v[200:203]
    v_mfma_f32_16x16x32_bf16 v[204:207], v[80:83], v[36:39], v[204:207]
    v_mfma_f32_16x16x32_bf16 v[208:211], v[84:87], v[24:27], v[208:211]
    v_mfma_f32_16x16x32_bf16 v[212:215], v[84:87], v[28:31], v[212:215]
    v_mfma_f32_16x16x32_bf16 v[216:219], v[84:87], v[32:35], v[216:219]
    v_mfma_f32_16x16x32_bf16 v[220:223], v[84:87], v[36:39], v[220:223]
    v_mfma_f32_16x16x32_bf16 v[224:227], v[88:91], v[24:27], v[224:227]
    v_mfma_f32_16x16x32_bf16 v[228:231], v[88:91], v[28:31], v[228:231]
    v_mfma_f32_16x16x32_bf16 v[232:235], v[88:91], v[32:35], v[232:235]
    v_mfma_f32_16x16x32_bf16 v[236:239], v[88:91], v[36:39], v[236:239]
    v_mfma_f32_16x16x32_bf16 v[240:243], v[92:95], v[24:27], v[240:243]
    v_mfma_f32_16x16x32_bf16 v[244:247], v[92:95], v[28:31], v[244:247]
    v_mfma_f32_16x16x32_bf16 v[248:251], v[92:95], v[32:35], v[248:251]
    v_mfma_f32_16x16x32_bf16 v[252:255], v[92:95], v[36:39], v[252:255]
    s_mul_i32 s47, s40, 14336
    s_add_u32 s47, s47, 61440
    v_add_u32 v5, s47, v126
    s_xor_b32 s46, s40, 1
    s_mul_i32 s46, s46, 14336
    s_add_u32 s46, s46, 61440
    v_add_u32 v6, s46, v126
    s_nop 4

    ds_write_b128 v5, v[152:155] offset:0
    ds_write_b128 v5, v[156:159] offset:1024
    ds_write_b128 v5, v[168:171] offset:2048
    ds_write_b128 v5, v[172:175] offset:3072
    ds_write_b128 v5, v[184:187] offset:4096
    ds_write_b128 v5, v[188:191] offset:5120
    ds_write_b128 v5, v[200:203] offset:6144
    ds_write_b128 v5, v[204:207] offset:7168
    ds_write_b128 v5, v[216:219] offset:8192
    ds_write_b128 v5, v[220:223] offset:9216
    ds_write_b128 v5, v[232:235] offset:10240
    ds_write_b128 v5, v[236:239] offset:11264
    ds_write_b128 v5, v[248:251] offset:12288
    ds_write_b128 v5, v[252:255] offset:13312
    s_waitcnt lgkmcnt(0)
    s_barrier
    ds_read_b128 v[8:11], v6 offset:0
    ds_read_b128 v[12:15], v6 offset:1024
    ds_read_b128 v[16:19], v6 offset:2048
    ds_read_b128 v[20:23], v6 offset:3072
    ds_read_b128 v[24:27], v6 offset:4096
    ds_read_b128 v[28:31], v6 offset:5120
    ds_read_b128 v[32:35], v6 offset:6144
    ds_read_b128 v[36:39], v6 offset:7168
    ds_read_b128 v[40:43], v6 offset:8192
    ds_read_b128 v[44:47], v6 offset:9216
    ds_read_b128 v[48:51], v6 offset:10240
    ds_read_b128 v[52:55], v6 offset:11264
    ds_read_b128 v[56:59], v6 offset:12288
    ds_read_b128 v[60:63], v6 offset:13312
    s_cmp_lg_u32 s38, 0
    s_waitcnt vmcnt(0)
    s_cbranch_scc1 L_k2y_21
    v_lshlrev_b32 v124, 16, v124
    v_lshlrev_b32 v125, 16, v125

    s_waitcnt lgkmcnt(13)
    v_add_f32 v8, v8, v144
    v_add_f32 v9, v9, v145
    v_add_f32 v10, v10, v146
    v_add_f32 v11, v11, v147
    v_add_f32 v8, v8, v124
    v_add_f32 v9, v9, v124
    v_add_f32 v10, v10, v124
    v_add_f32 v11, v11, v124
    v_lshlrev_b32 v92, 16, v96
    v_and_b32 v93, 0xffff0000, v96
    v_lshlrev_b32 v94, 16, v97
    v_and_b32 v95, 0xffff0000, v97
    v_mul_f32 v8, v8, v92
    v_mul_f32 v9, v9, v93
    v_mul_f32 v10, v10, v94
    v_mul_f32 v11, v11, v95

    v_cvt_pk_bf16_f32 v64, v8, v9
    v_cvt_pk_bf16_f32 v65, v10, v11
    s_waitcnt lgkmcnt(12)
    v_add_f32 v12, v12, v148
    v_add_f32 v13, v13, v149
    v_add_f32 v14, v14, v150
    v_add_f32 v15, v15, v151
    v_add_f32 v12, v12, v125
    v_add_f32 v13, v13, v125
    v_add_f32 v14, v14, v125
    v_add_f32 v15, v15, v125
    v_lshlrev_b32 v92, 16, v110
    v_and_b32 v93, 0xffff0000, v110
    v_lshlrev_b32 v94, 16, v111
    v_and_b32 v95, 0xffff0000, v111
    v_mul_f32 v12, v12, v92
    v_mul_f32 v13, v13, v93
    v_mul_f32 v14, v14, v94
    v_mul_f32 v15, v15, v95

    v_cvt_pk_bf16_f32 v78, v12, v13
    v_cvt_pk_bf16_f32 v79, v14, v15
    s_waitcnt lgkmcnt(11)
    v_add_f32 v16, v16, v160
    v_add_f32 v17, v17, v161
    v_add_f32 v18, v18, v162
    v_add_f32 v19, v19, v163
    v_add_f32 v16, v16, v124
    v_add_f32 v17, v17, v124
    v_add_f32 v18, v18, v124
    v_add_f32 v19, v19, v124
    v_lshlrev_b32 v92, 16, v98
    v_and_b32 v93, 0xffff0000, v98
    v_lshlrev_b32 v94, 16, v99
    v_and_b32 v95, 0xffff0000, v99
    v_mul_f32 v16, v16, v92
    v_mul_f32 v17, v17, v93
    v_mul_f32 v18, v18, v94
    v_mul_f32 v19, v19, v95

    v_cvt_pk_bf16_f32 v66, v16, v17
    v_cvt_pk_bf16_f32 v67, v18, v19
    buffer_store_dwordx4 v[64:67], v126, s[20:23], s48 offen offset:0 sc1
    s_waitcnt lgkmcnt(10)
    v_add_f32 v20, v20, v164
    v_add_f32 v21, v21, v165
    v_add_f32 v22, v22, v166
    v_add_f32 v23, v23, v167
    v_add_f32 v20, v20, v125
    v_add_f32 v21, v21, v125
    v_add_f32 v22, v22, v125
    v_add_f32 v23, v23, v125
    v_lshlrev_b32 v92, 16, v112
    v_and_b32 v93, 0xffff0000, v112
    v_lshlrev_b32 v94, 16, v113
    v_and_b32 v95, 0xffff0000, v113
    v_mul_f32 v20, v20, v92
    v_mul_f32 v21, v21, v93
    v_mul_f32 v22, v22, v94
    v_mul_f32 v23, v23, v95

    v_cvt_pk_bf16_f32 v80, v20, v21
    v_cvt_pk_bf16_f32 v81, v22, v23
    buffer_store_dwordx4 v[78:81], v126, s[20:23], s49 offen offset:0 sc1
    s_waitcnt lgkmcnt(9)
    v_add_f32 v24, v24, v176
    v_add_f32 v25, v25, v177
    v_add_f32 v26, v26, v178
    v_add_f32 v27, v27, v179
    v_add_f32 v24, v24, v124
    v_add_f32 v25, v25, v124
    v_add_f32 v26, v26, v124
    v_add_f32 v27, v27, v124
    v_lshlrev_b32 v92, 16, v100
    v_and_b32 v93, 0xffff0000, v100
    v_lshlrev_b32 v94, 16, v101
    v_and_b32 v95, 0xffff0000, v101
    v_mul_f32 v24, v24, v92
    v_mul_f32 v25, v25, v93
    v_mul_f32 v26, v26, v94
    v_mul_f32 v27, v27, v95

    v_cvt_pk_bf16_f32 v68, v24, v25
    v_cvt_pk_bf16_f32 v69, v26, v27
    s_waitcnt lgkmcnt(8)
    v_add_f32 v28, v28, v180
    v_add_f32 v29, v29, v181
    v_add_f32 v30, v30, v182
    v_add_f32 v31, v31, v183
    v_add_f32 v28, v28, v125
    v_add_f32 v29, v29, v125
    v_add_f32 v30, v30, v125
    v_add_f32 v31, v31, v125
    v_lshlrev_b32 v92, 16, v114
    v_and_b32 v93, 0xffff0000, v114
    v_lshlrev_b32 v94, 16, v115
    v_and_b32 v95, 0xffff0000, v115
    v_mul_f32 v28, v28, v92
    v_mul_f32 v29, v29, v93
    v_mul_f32 v30, v30, v94
    v_mul_f32 v31, v31, v95

    v_cvt_pk_bf16_f32 v82, v28, v29
    v_cvt_pk_bf16_f32 v83, v30, v31
    s_waitcnt lgkmcnt(7)
    v_add_f32 v32, v32, v192
    v_add_f32 v33, v33, v193
    v_add_f32 v34, v34, v194
    v_add_f32 v35, v35, v195
    v_add_f32 v32, v32, v124
    v_add_f32 v33, v33, v124
    v_add_f32 v34, v34, v124
    v_add_f32 v35, v35, v124
    v_lshlrev_b32 v92, 16, v102
    v_and_b32 v93, 0xffff0000, v102
    v_lshlrev_b32 v94, 16, v103
    v_and_b32 v95, 0xffff0000, v103
    v_mul_f32 v32, v32, v92
    v_mul_f32 v33, v33, v93
    v_mul_f32 v34, v34, v94
    v_mul_f32 v35, v35, v95

    v_cvt_pk_bf16_f32 v70, v32, v33
    v_cvt_pk_bf16_f32 v71, v34, v35
    buffer_store_dwordx4 v[68:71], v126, s[20:23], s48 offen offset:1024 sc1
    s_waitcnt lgkmcnt(6)
    v_add_f32 v36, v36, v196
    v_add_f32 v37, v37, v197
    v_add_f32 v38, v38, v198
    v_add_f32 v39, v39, v199
    v_add_f32 v36, v36, v125
    v_add_f32 v37, v37, v125
    v_add_f32 v38, v38, v125
    v_add_f32 v39, v39, v125
    v_lshlrev_b32 v92, 16, v116
    v_and_b32 v93, 0xffff0000, v116
    v_lshlrev_b32 v94, 16, v117
    v_and_b32 v95, 0xffff0000, v117
    v_mul_f32 v36, v36, v92
    v_mul_f32 v37, v37, v93
    v_mul_f32 v38, v38, v94
    v_mul_f32 v39, v39, v95

    v_cvt_pk_bf16_f32 v84, v36, v37
    v_cvt_pk_bf16_f32 v85, v38, v39
    buffer_store_dwordx4 v[82:85], v126, s[20:23], s49 offen offset:1024 sc1
    s_waitcnt lgkmcnt(5)
    v_add_f32 v40, v40, v208
    v_add_f32 v41, v41, v209
    v_add_f32 v42, v42, v210
    v_add_f32 v43, v43, v211
    v_add_f32 v40, v40, v124
    v_add_f32 v41, v41, v124
    v_add_f32 v42, v42, v124
    v_add_f32 v43, v43, v124
    v_lshlrev_b32 v92, 16, v104
    v_and_b32 v93, 0xffff0000, v104
    v_lshlrev_b32 v94, 16, v105
    v_and_b32 v95, 0xffff0000, v105
    v_mul_f32 v40, v40, v92
    v_mul_f32 v41, v41, v93
    v_mul_f32 v42, v42, v94
    v_mul_f32 v43, v43, v95

    v_cvt_pk_bf16_f32 v72, v40, v41
    v_cvt_pk_bf16_f32 v73, v42, v43
    s_waitcnt lgkmcnt(4)
    v_add_f32 v44, v44, v212
    v_add_f32 v45, v45, v213
    v_add_f32 v46, v46, v214
    v_add_f32 v47, v47, v215
    v_add_f32 v44, v44, v125
    v_add_f32 v45, v45, v125
    v_add_f32 v46, v46, v125
    v_add_f32 v47, v47, v125
    v_lshlrev_b32 v92, 16, v118
    v_and_b32 v93, 0xffff0000, v118
    v_lshlrev_b32 v94, 16, v119
    v_and_b32 v95, 0xffff0000, v119
    v_mul_f32 v44, v44, v92
    v_mul_f32 v45, v45, v93
    v_mul_f32 v46, v46, v94
    v_mul_f32 v47, v47, v95

    v_cvt_pk_bf16_f32 v86, v44, v45
    v_cvt_pk_bf16_f32 v87, v46, v47
    s_waitcnt lgkmcnt(3)
    v_add_f32 v48, v48, v224
    v_add_f32 v49, v49, v225
    v_add_f32 v50, v50, v226
    v_add_f32 v51, v51, v227
    v_add_f32 v48, v48, v124
    v_add_f32 v49, v49, v124
    v_add_f32 v50, v50, v124
    v_add_f32 v51, v51, v124
    v_lshlrev_b32 v92, 16, v106
    v_and_b32 v93, 0xffff0000, v106
    v_lshlrev_b32 v94, 16, v107
    v_and_b32 v95, 0xffff0000, v107
    v_mul_f32 v48, v48, v92
    v_mul_f32 v49, v49, v93
    v_mul_f32 v50, v50, v94
    v_mul_f32 v51, v51, v95

    v_cvt_pk_bf16_f32 v74, v48, v49
    v_cvt_pk_bf16_f32 v75, v50, v51
    buffer_store_dwordx4 v[72:75], v126, s[20:23], s48 offen offset:2048 sc1
    s_waitcnt lgkmcnt(2)
    v_add_f32 v52, v52, v228
    v_add_f32 v53, v53, v229
    v_add_f32 v54, v54, v230
    v_add_f32 v55, v55, v231
    v_add_f32 v52, v52, v125
    v_add_f32 v53, v53, v125
    v_add_f32 v54, v54, v125
    v_add_f32 v55, v55, v125
    v_lshlrev_b32 v92, 16, v120
    v_and_b32 v93, 0xffff0000, v120
    v_lshlrev_b32 v94, 16, v121
    v_and_b32 v95, 0xffff0000, v121
    v_mul_f32 v52, v52, v92
    v_mul_f32 v53, v53, v93
    v_mul_f32 v54, v54, v94
    v_mul_f32 v55, v55, v95

    v_cvt_pk_bf16_f32 v88, v52, v53
    v_cvt_pk_bf16_f32 v89, v54, v55
    buffer_store_dwordx4 v[86:89], v126, s[20:23], s49 offen offset:2048 sc1
    s_waitcnt lgkmcnt(1)
    v_add_f32 v56, v56, v240
    v_add_f32 v57, v57, v241
    v_add_f32 v58, v58, v242
    v_add_f32 v59, v59, v243
    v_add_f32 v56, v56, v124
    v_add_f32 v57, v57, v124
    v_add_f32 v58, v58, v124
    v_add_f32 v59, v59, v124
    v_lshlrev_b32 v92, 16, v108
    v_and_b32 v93, 0xffff0000, v108
    v_lshlrev_b32 v94, 16, v109
    v_and_b32 v95, 0xffff0000, v109
    v_mul_f32 v56, v56, v92
    v_mul_f32 v57, v57, v93
    v_mul_f32 v58, v58, v94
    v_mul_f32 v59, v59, v95

    v_cvt_pk_bf16_f32 v76, v56, v57
    v_cvt_pk_bf16_f32 v77, v58, v59
    buffer_store_dwordx2 v[76:77], v126, s[20:23], s50 offen sc1
    s_waitcnt lgkmcnt(0)
    v_add_f32 v60, v60, v244
    v_add_f32 v61, v61, v245
    v_add_f32 v62, v62, v246
    v_add_f32 v63, v63, v247
    v_add_f32 v60, v60, v125
    v_add_f32 v61, v61, v125
    v_add_f32 v62, v62, v125
    v_add_f32 v63, v63, v125
    v_lshlrev_b32 v92, 16, v122
    v_and_b32 v93, 0xffff0000, v122
    v_lshlrev_b32 v94, 16, v123
    v_and_b32 v95, 0xffff0000, v123
    v_mul_f32 v60, v60, v92
    v_mul_f32 v61, v61, v93
    v_mul_f32 v62, v62, v94
    v_mul_f32 v63, v63, v95

    v_cvt_pk_bf16_f32 v90, v60, v61
    v_cvt_pk_bf16_f32 v91, v62, v63
    buffer_store_dwordx2 v[90:91], v126, s[20:23], s51 offen sc1
    s_barrier
    s_endpgm
L_k2y_21:
    s_waitcnt lgkmcnt(13)
    v_add_f32 v8, v8, v144
    v_add_f32 v9, v9, v145
    v_add_f32 v10, v10, v146
    v_add_f32 v11, v11, v147
    v_cvt_pk_bf16_f32 v64, v8, v9
    v_cvt_pk_bf16_f32 v65, v10, v11
    s_waitcnt lgkmcnt(12)
    v_add_f32 v12, v12, v148
    v_add_f32 v13, v13, v149
    v_add_f32 v14, v14, v150
    v_add_f32 v15, v15, v151
    v_cvt_pk_bf16_f32 v78, v12, v13
    v_cvt_pk_bf16_f32 v79, v14, v15
    s_waitcnt lgkmcnt(11)
    v_add_f32 v16, v16, v160
    v_add_f32 v17, v17, v161
    v_add_f32 v18, v18, v162
    v_add_f32 v19, v19, v163
    v_cvt_pk_bf16_f32 v66, v16, v17
    v_cvt_pk_bf16_f32 v67, v18, v19
    buffer_store_dwordx4 v[64:67], v126, s[20:23], s48 offen offset:0 sc1
    s_waitcnt lgkmcnt(10)
    v_add_f32 v20, v20, v164
    v_add_f32 v21, v21, v165
    v_add_f32 v22, v22, v166
    v_add_f32 v23, v23, v167
    v_cvt_pk_bf16_f32 v80, v20, v21
    v_cvt_pk_bf16_f32 v81, v22, v23
    buffer_store_dwordx4 v[78:81], v126, s[20:23], s49 offen offset:0 sc1
    s_waitcnt lgkmcnt(9)
    v_add_f32 v24, v24, v176
    v_add_f32 v25, v25, v177
    v_add_f32 v26, v26, v178
    v_add_f32 v27, v27, v179
    v_cvt_pk_bf16_f32 v68, v24, v25
    v_cvt_pk_bf16_f32 v69, v26, v27
    s_waitcnt lgkmcnt(8)
    v_add_f32 v28, v28, v180
    v_add_f32 v29, v29, v181
    v_add_f32 v30, v30, v182
    v_add_f32 v31, v31, v183
    v_cvt_pk_bf16_f32 v82, v28, v29
    v_cvt_pk_bf16_f32 v83, v30, v31
    s_waitcnt lgkmcnt(7)
    v_add_f32 v32, v32, v192
    v_add_f32 v33, v33, v193
    v_add_f32 v34, v34, v194
    v_add_f32 v35, v35, v195
    v_cvt_pk_bf16_f32 v70, v32, v33
    v_cvt_pk_bf16_f32 v71, v34, v35
    buffer_store_dwordx4 v[68:71], v126, s[20:23], s48 offen offset:1024 sc1
    s_waitcnt lgkmcnt(6)
    v_add_f32 v36, v36, v196
    v_add_f32 v37, v37, v197
    v_add_f32 v38, v38, v198
    v_add_f32 v39, v39, v199
    v_cvt_pk_bf16_f32 v84, v36, v37
    v_cvt_pk_bf16_f32 v85, v38, v39
    buffer_store_dwordx4 v[82:85], v126, s[20:23], s49 offen offset:1024 sc1
    s_waitcnt lgkmcnt(5)
    v_add_f32 v40, v40, v208
    v_add_f32 v41, v41, v209
    v_add_f32 v42, v42, v210
    v_add_f32 v43, v43, v211
    v_cvt_pk_bf16_f32 v72, v40, v41
    v_cvt_pk_bf16_f32 v73, v42, v43
    s_waitcnt lgkmcnt(4)
    v_add_f32 v44, v44, v212
    v_add_f32 v45, v45, v213
    v_add_f32 v46, v46, v214
    v_add_f32 v47, v47, v215
    v_cvt_pk_bf16_f32 v86, v44, v45
    v_cvt_pk_bf16_f32 v87, v46, v47
    s_waitcnt lgkmcnt(3)
    v_add_f32 v48, v48, v224
    v_add_f32 v49, v49, v225
    v_add_f32 v50, v50, v226
    v_add_f32 v51, v51, v227
    v_cvt_pk_bf16_f32 v74, v48, v49
    v_cvt_pk_bf16_f32 v75, v50, v51
    buffer_store_dwordx4 v[72:75], v126, s[20:23], s48 offen offset:2048 sc1
    s_waitcnt lgkmcnt(2)
    v_add_f32 v52, v52, v228
    v_add_f32 v53, v53, v229
    v_add_f32 v54, v54, v230
    v_add_f32 v55, v55, v231
    v_cvt_pk_bf16_f32 v88, v52, v53
    v_cvt_pk_bf16_f32 v89, v54, v55
    buffer_store_dwordx4 v[86:89], v126, s[20:23], s49 offen offset:2048 sc1
    s_waitcnt lgkmcnt(1)
    v_add_f32 v56, v56, v240
    v_add_f32 v57, v57, v241
    v_add_f32 v58, v58, v242
    v_add_f32 v59, v59, v243
    v_cvt_pk_bf16_f32 v76, v56, v57
    v_cvt_pk_bf16_f32 v77, v58, v59
    buffer_store_dwordx2 v[76:77], v126, s[20:23], s50 offen sc1
    s_waitcnt lgkmcnt(0)
    v_add_f32 v60, v60, v244
    v_add_f32 v61, v61, v245
    v_add_f32 v62, v62, v246
    v_add_f32 v63, v63, v247
    v_cvt_pk_bf16_f32 v90, v60, v61
    v_cvt_pk_bf16_f32 v91, v62, v63
    buffer_store_dwordx2 v[90:91], v126, s[20:23], s51 offen sc1
    s_waitcnt vmcnt(0)
    s_barrier
    s_endpgm
L_k2load_18:
    s_sub_u32 s42, s40, 4
    v_lshrrev_b32 v1, 5, v0
    v_lshlrev_b32 v1, 3, v1
    v_bfe_u32 v2, v0, 3, 2
    v_add_u32 v1, v1, v2
    s_lshl_b32 s43, s42, 5
    v_add_u32 v1, s43, v1
    v_lshlrev_b32 v1, 12, v1
    v_and_b32 v2, 7, v0
    v_lshrrev_b32 v3, 4, v0
    v_xor_b32 v2, v2, v3
    v_lshlrev_b32 v2, 4, v2
    v_xor_b32 v3, 64, v2
    v_add_u32 v4, v1, v2
    v_add_u32 v5, v1, v3
    v_add_u32 v5, 64512, v5
    v_add_u32 v6, 14336, v4
    v_add_u32 v7, 14336, v5
    s_lshl_b32 s43, s42, 2
    s_cmp_eq_u32 s42, 3
    s_cselect_b32 s43, 11, s43
    s_lshl_b32 s43, s43, 10
    v_lshlrev_b32 v8, 4, v0
    v_add_u32 v8, s43, v8
    s_lshl_b32 s44, s42, 12
    s_add_u32 s45, s43, 16384
    s_mov_b32 s46, 0

    s_add_u32 s50, s36, s37
    s_and_b32 s50, s50, 3
    s_mov_b32 s28, 0x2222223
    s_cmp_eq_u32 s50, 1
    s_cselect_b32 s28, 0x4444445, s28
    s_cmp_eq_u32 s50, 2
    s_cselect_b32 s28, 0x8888889, s28
    s_cmp_eq_u32 s50, 3
    s_cselect_b32 s28, 0x11111111, s28
    s_mov_b32 s100, s28
    s_mov_b32 s101, s50
    s_cmp_eq_u32 s50, 0
    s_cselect_b32 s51, 1, 0

    s_bitcmp1_b32 s100, 0
    s_cselect_b32 s47, s101, s51
    s_cselect_b32 s48, 4, 0
    s_cselect_b32 s24, 0, 1
    s_add_u32 s101, s101, s48
    s_add_u32 s51, s51, s24
    s_and_b32 s24, s51, 3
    s_cmp_eq_u32 s24, s50
    s_addc_u32 s51, s51, 0
    s_lshr_b32 s100, s100, 1
    s_mul_i32 s48, s47, 14336
    s_lshl_b32 s47, s47, 7
    s_cmp_ge_u32 s42, 2
    s_cbranch_scc1 L_k2ldB_23
    s_add_u32 s16, s32, 24182784
    s_addc_u32 s17, s33, 0
    s_mov_b32 s18, 32768
    s_mov_b32 s19, 0x20000
    s_movk_i32 s22, 256
    s_mov_b32 s23, 0x20000

    s_mul_i32 s24, s37, 7
    s_add_u32 s25, s24, 6
    s_lshr_b32 s24, s24, 2
    s_lshr_b32 s25, s25, 2
    v_and_b32 v25, 3, v0
    v_add_u32 v25, s24, v25
    v_min_u32 v25, s25, v25
    v_lshrrev_b32 v24, 2, v0
    v_lshl_add_u32 v24, v24, 4, v25
    v_lshlrev_b32 v24, 7, v24

    v_cmp_eq_u32 vcc, s62, v24
    s_nop 1
    v_cndmask_b32 v27, 0, 1, vcc
    v_mov_b32 v14, 0x01010101
    v_min_u32 v21, 7, v0
    v_lshlrev_b32 v21, 2, v21
    v_add_u32 v21, 128, v21
    v_mov_b32 v26, 0
    s_mov_b32 s26, 20000
    s_cmp_lg_u32 s42, 0
    s_cbranch_scc1 L_k2bx_25

L_k2bd_27:
    v_cmp_ne_u32 vcc, v14, v20
    s_cbranch_vccz L_k2bb_26
    s_sleep 32
    buffer_load_dword v20, v21, s[20:23], 0 offen sc1
    s_sub_u32 s26, s26, 1
    s_cmp_gt_i32 s26, 0
    s_waitcnt vmcnt(0)
    s_cbranch_scc1 L_k2bd_27

L_k2bb_26:
    buffer_load_dword v26, v24, s[16:19], 0 offen sc1
L_k2bx_25:
    s_mov_b32 s49, 5
L_k2pro_28:
    s_add_u32 m0, s46, s44
    s_nop 0

    buffer_load_dwordx4 v4, s[8:11], s47 offen  lds
    buffer_load_dwordx4 v5, s[8:11], s47 offen offset:1024  lds
    buffer_load_dwordx4 v6, s[8:11], s47 offen offset:2048  lds
    buffer_load_dwordx4 v7, s[8:11], s47 offen offset:3072  lds

    s_add_u32 m0, s46, s45
    s_add_u32 s47, s47, 128

    s_bitcmp1_b32 s100, 0
    s_cselect_b32 s47, s101, s51
    s_cselect_b32 s48, 4, 0
    s_cselect_b32 s24, 0, 1
    s_add_u32 s101, s101, s48
    s_add_u32 s51, s51, s24
    s_and_b32 s24, s51, 3
    s_cmp_eq_u32 s24, s50
    s_addc_u32 s51, s51, 0
    s_lshr_b32 s100, s100, 1
    s_mul_i32 s48, s47, 14336
    s_lshl_b32 s47, s47, 7
    s_add_u32 s46, s46, 30720
    s_cmp_eq_u32 s46, 153600
    s_cselect_b32 s46, 0, s46

    s_sub_u32 s49, s49, 1
    s_cmp_lg_u32 s49, 0
    s_cbranch_scc1 L_k2pro_28

    s_load_dwordx2 s[92:93], s[0:1], 88
    s_lshl_b32 s57, s38, 3
    s_add_u32 s57, s57, s37
    s_mul_i32 s96, s36, 2048
    s_lshl_b32 s58, s57, 7
    s_add_u32 s97, s96, s57
    s_add_u32 s96, s96, s58
    s_cmp_ge_u32 s57, 7
    s_cselect_b32 s58, 1, 0
    s_cselect_b32 s59, 7, 0
    s_lshl_b32 s52, s36, 1
    s_add_u32 s52, s52, s58
    s_sub_u32 s53, s57, s59
    s_mul_i32 s55, s42, 7168
    s_lshl_b32 s56, s52, 2
    v_lshlrev_b32 v2, 4, v0
    v_add_u32 v3, 0x1000, v2

    s_add_u32 s58, s42, 0
    s_and_b32 s58, s58, 3
    s_add_u32 s58, s58, s56
    s_mul_i32 s58, s58, 28672
    s_add_u32 s60, s58, s55

    s_add_u32 s58, s42, 1
    s_and_b32 s58, s58, 3
    s_add_u32 s58, s58, s56
    s_mul_i32 s58, s58, 28672
    s_add_u32 s61, s58, s55

    s_add_u32 s58, s42, 2
    s_and_b32 s58, s58, 3
    s_add_u32 s58, s58, s56
    s_mul_i32 s58, s58, 28672
    s_add_u32 s62, s58, s55

    s_add_u32 s58, s42, 3
    s_and_b32 s58, s58, 3
    s_add_u32 s58, s58, s56
    s_mul_i32 s58, s58, 28672
    s_add_u32 s63, s58, s55

    s_mul_i32 s58, s53, 114688
    s_add_u32 s64, s58, s55
    s_add_u32 s65, s64, 28672
    s_add_u32 s66, s65, 28672
    s_add_u32 s67, s66, 28672
    s_add_u32 s68, s32, 12582912
    s_addc_u32 s69, s33, 0
    s_mov_b32 s70, 3670016
    s_mov_b32 s71, 0x20000
    s_add_u32 s72, s32, 20971520
    s_addc_u32 s73, s33, 0
    s_mov_b32 s74, 802816
    s_mov_b32 s75, 0x20000
    s_add_u32 s76, s32, 16777216
    s_addc_u32 s77, s33, 0
    s_mov_b32 s78, 3670016
    s_mov_b32 s79, 0x20000
    s_add_u32 s80, s32, 22020096
    s_addc_u32 s81, s33, 0
    s_mov_b32 s82, 8192
    s_mov_b32 s83, 0x20000
    s_waitcnt lgkmcnt(0)
    s_mov_b32 s84, s92
    s_mov_b32 s85, s93
    s_mov_b32 s86, 1835008
    s_mov_b32 s87, 0x20000
    s_add_u32 s88, s32, 24117248
    s_addc_u32 s89, s33, 0
    s_mov_b32 s90, 32768
    s_mov_b32 s91, 0x20000

    s_cmp_lg_u32 s42, 0
    s_cbranch_scc1 L_k2bx_29
    s_waitcnt vmcnt(20)
    s_branch L_k2bc_31

L_k2bb_30:
    buffer_load_dword v26, v24, s[16:19], 0 offen sc1
    s_waitcnt vmcnt(0)

L_k2bc_31:
    v_or_b32 v26, v26, v27
    v_cmp_ne_u32 vcc, 1, v26
    s_cbranch_vccz L_k2bx_29
    s_sleep 1

    s_bcnt1_i32_b64 s27, vcc
    s_cmp_le_u32 s27, 48
    s_cbranch_scc1 L_k2bs_32
    s_sleep 32

L_k2bs_32:
    s_sub_u32 s26, s26, 1
    s_cmp_gt_i32 s26, 0
    s_cbranch_scc1 L_k2bb_30

L_k2bx_29:
    s_mov_b32 s100, s28
    s_mov_b32 s101, s50
    s_cmp_eq_u32 s50, 0
    s_cselect_b32 s51, 1, 0

    s_bitcmp1_b32 s100, 0
    s_cselect_b32 s47, s101, s51
    s_cselect_b32 s48, 4, 0
    s_cselect_b32 s24, 0, 1
    s_add_u32 s101, s101, s48
    s_add_u32 s51, s51, s24
    s_and_b32 s24, s51, 3
    s_cmp_eq_u32 s24, s50
    s_addc_u32 s51, s51, 0
    s_lshr_b32 s100, s100, 1
    s_mul_i32 s48, s47, 14336
    s_lshl_b32 s47, s47, 7
    s_mov_b32 s46, 0
    s_barrier
    s_mov_b32 s49, 5
L_k2pro_33:
    s_add_u32 m0, s46, s44
    s_nop 0

    s_add_u32 m0, s46, s45
    s_add_u32 s47, s47, 128

    buffer_load_dwordx4 v8, s[12:15], s48 offen offset:0  lds
    buffer_load_dwordx4 v8, s[12:15], s48 offen offset:1024  lds
    buffer_load_dwordx4 v8, s[12:15], s48 offen offset:2048  lds
    buffer_load_dwordx4 v8, s[12:15], s48 offen offset:3072  lds
    s_bitcmp1_b32 s100, 0
    s_cselect_b32 s47, s101, s51
    s_cselect_b32 s48, 4, 0
    s_cselect_b32 s24, 0, 1
    s_add_u32 s101, s101, s48
    s_add_u32 s51, s51, s24
    s_and_b32 s24, s51, 3
    s_cmp_eq_u32 s24, s50
    s_addc_u32 s51, s51, 0
    s_lshr_b32 s100, s100, 1
    s_mul_i32 s48, s47, 14336
    s_lshl_b32 s47, s47, 7
    s_add_u32 s46, s46, 30720
    s_cmp_eq_u32 s46, 153600
    s_cselect_b32 s46, 0, s46

    s_sub_u32 s49, s49, 1
    s_cmp_lg_u32 s49, 0
    s_cbranch_scc1 L_k2pro_33

    s_waitcnt vmcnt(16)
    s_barrier
    s_waitcnt vmcnt(12)
    s_barrier
    s_add_u32 m0, s46, s44
    s_nop 0

    buffer_load_dwordx4 v4, s[8:11], s47 offen  lds
    buffer_load_dwordx4 v5, s[8:11], s47 offen offset:1024  lds
    buffer_load_dwordx4 v6, s[8:11], s47 offen offset:2048  lds
    buffer_load_dwordx4 v7, s[8:11], s47 offen offset:3072  lds

    s_add_u32 m0, s46, s45
    s_add_u32 s47, s47, 128

    buffer_load_dwordx4 v8, s[12:15], s48 offen offset:0  lds
    buffer_load_dwordx4 v8, s[12:15], s48 offen offset:1024  lds
    buffer_load_dwordx4 v8, s[12:15], s48 offen offset:2048  lds
    buffer_load_dwordx4 v8, s[12:15], s48 offen offset:3072  lds
    s_bitcmp1_b32 s100, 0
    s_cselect_b32 s47, s101, s51
    s_cselect_b32 s48, 4, 0
    s_cselect_b32 s24, 0, 1
    s_add_u32 s101, s101, s48
    s_add_u32 s51, s51, s24
    s_and_b32 s24, s51, 3
    s_cmp_eq_u32 s24, s50
    s_addc_u32 s51, s51, 0
    s_lshr_b32 s100, s100, 1
    s_mul_i32 s48, s47, 14336
    s_lshl_b32 s47, s47, 7
    s_add_u32 s46, s46, 30720
    s_cmp_eq_u32 s46, 153600
    s_cselect_b32 s46, 0, s46

    s_waitcnt vmcnt(16)
    s_barrier
    s_add_u32 m0, s46, s44
    s_nop 0

    buffer_load_dwordx4 v4, s[8:11], s47 offen  lds
    buffer_load_dwordx4 v5, s[8:11], s47 offen offset:1024  lds
    buffer_load_dwordx4 v6, s[8:11], s47 offen offset:2048  lds
    buffer_load_dwordx4 v7, s[8:11], s47 offen offset:3072  lds

    s_add_u32 m0, s46, s45
    s_add_u32 s47, s47, 128

    buffer_load_dwordx4 v8, s[12:15], s48 offen offset:0  lds
    buffer_load_dwordx4 v8, s[12:15], s48 offen offset:1024  lds
    buffer_load_dwordx4 v8, s[12:15], s48 offen offset:2048  lds
    buffer_load_dwordx4 v8, s[12:15], s48 offen offset:3072  lds
    s_bitcmp1_b32 s100, 0
    s_cselect_b32 s47, s101, s51
    s_cselect_b32 s48, 4, 0
    s_cselect_b32 s24, 0, 1
    s_add_u32 s101, s101, s48
    s_add_u32 s51, s51, s24
    s_and_b32 s24, s51, 3
    s_cmp_eq_u32 s24, s50
    s_addc_u32 s51, s51, 0
    s_lshr_b32 s100, s100, 1
    s_mul_i32 s48, s47, 14336
    s_lshl_b32 s47, s47, 7
    s_add_u32 s46, s46, 30720
    s_cmp_eq_u32 s46, 153600
    s_cselect_b32 s46, 0, s46

    s_waitcnt vmcnt(20)
    s_barrier
    s_add_u32 m0, s46, s44
    s_nop 0

    buffer_load_dwordx4 v4, s[8:11], s47 offen  lds
    buffer_load_dwordx4 v5, s[8:11], s47 offen offset:1024  lds
    buffer_load_dwordx4 v6, s[8:11], s47 offen offset:2048  lds
    buffer_load_dwordx4 v7, s[8:11], s47 offen offset:3072  lds

    s_add_u32 m0, s46, s45
    s_add_u32 s47, s47, 128

    buffer_load_dwordx4 v8, s[12:15], s48 offen offset:0  lds
    buffer_load_dwordx4 v8, s[12:15], s48 offen offset:1024  lds
    buffer_load_dwordx4 v8, s[12:15], s48 offen offset:2048  lds
    buffer_load_dwordx4 v8, s[12:15], s48 offen offset:3072  lds
    s_bitcmp1_b32 s100, 0
    s_cselect_b32 s47, s101, s51
    s_cselect_b32 s48, 4, 0
    s_cselect_b32 s24, 0, 1
    s_add_u32 s101, s101, s48
    s_add_u32 s51, s51, s24
    s_and_b32 s24, s51, 3
    s_cmp_eq_u32 s24, s50
    s_addc_u32 s51, s51, 0
    s_lshr_b32 s100, s100, 1
    s_mul_i32 s48, s47, 14336
    s_lshl_b32 s47, s47, 7
    s_add_u32 s46, s46, 30720
    s_cmp_eq_u32 s46, 153600
    s_cselect_b32 s46, 0, s46

    s_cmp_lg_u32 s42, 0
    s_cbranch_scc1 L_k2dq_34
    buffer_load_dword v15, v21, s[20:23], 0 offen sc1
L_k2dq_34:
    s_mov_b32 s49, 24
L_k2ldloop_35:
    s_waitcnt vmcnt(24)
    s_barrier
    s_add_u32 m0, s46, s44
    s_nop 0

    buffer_load_dwordx4 v4, s[8:11], s47 offen  lds
    buffer_load_dwordx4 v5, s[8:11], s47 offen offset:1024  lds
    buffer_load_dwordx4 v6, s[8:11], s47 offen offset:2048  lds
    buffer_load_dwordx4 v7, s[8:11], s47 offen offset:3072  lds

    s_add_u32 m0, s46, s45
    s_add_u32 s47, s47, 128

    buffer_load_dwordx4 v8, s[12:15], s48 offen offset:0  lds
    buffer_load_dwordx4 v8, s[12:15], s48 offen offset:1024  lds
    buffer_load_dwordx4 v8, s[12:15], s48 offen offset:2048  lds
    buffer_load_dwordx4 v8, s[12:15], s48 offen offset:3072  lds
    s_bitcmp1_b32 s100, 0
    s_cselect_b32 s47, s101, s51
    s_cselect_b32 s48, 4, 0
    s_cselect_b32 s24, 0, 1
    s_add_u32 s101, s101, s48
    s_add_u32 s51, s51, s24
    s_and_b32 s24, s51, 3
    s_cmp_eq_u32 s24, s50
    s_addc_u32 s51, s51, 0
    s_lshr_b32 s100, s100, 1
    s_mul_i32 s48, s47, 14336
    s_lshl_b32 s47, s47, 7
    s_add_u32 s46, s46, 30720
    s_cmp_eq_u32 s46, 153600
    s_cselect_b32 s46, 0, s46

    s_sub_u32 s49, s49, 1
    s_cmp_lg_u32 s49, 0
    s_cbranch_scc1 L_k2ldloop_35

    s_cmp_lg_u32 s42, 0
    s_cbranch_scc1 L_k2dq_36
L_k2bd_37:
    v_cmp_ne_u32 vcc, v14, v15
    s_cbranch_vccz L_k2dq_36
    s_sleep 32
    buffer_load_dword v15, v21, s[20:23], 0 offen sc1
    s_sub_u32 s26, s26, 1
    s_cmp_gt_i32 s26, 0
    s_waitcnt vmcnt(0)
    s_cbranch_scc1 L_k2bd_37

L_k2dq_36:
    s_cmp_ge_u32 s53, 7
    s_cbranch_scc1 L_k2nt_38
    s_waitcnt vmcnt(24)
    s_barrier
    buffer_load_dwordx4 v[16:19], v2, s[72:75], s64 offen offset:0
    buffer_load_dwordx4 v[20:23], v2, s[72:75], s65 offen offset:0
    buffer_load_dwordx4 v[24:27], v2, s[72:75], s66 offen offset:0
    buffer_load_dwordx4 v[28:31], v2, s[72:75], s67 offen offset:0
    buffer_load_dwordx4 v[32:35], v2, s[72:75], s64 offen offset:1024
    buffer_load_dwordx4 v[36:39], v2, s[72:75], s65 offen offset:1024
    buffer_load_dwordx4 v[40:43], v2, s[72:75], s66 offen offset:1024
    s_waitcnt vmcnt(23)
    s_barrier
    buffer_load_dwordx4 v[44:47], v2, s[72:75], s67 offen offset:1024
    buffer_load_dwordx4 v[48:51], v2, s[72:75], s64 offen offset:2048
    buffer_load_dwordx4 v[52:55], v2, s[72:75], s65 offen offset:2048
    buffer_load_dwordx4 v[56:59], v2, s[72:75], s66 offen offset:2048
    buffer_load_dwordx4 v[60:63], v2, s[72:75], s67 offen offset:2048
    buffer_load_dwordx4 v[64:67], v2, s[72:75], s64 offen offset:3072
    buffer_load_dwordx4 v[68:71], v2, s[72:75], s65 offen offset:3072
    s_waitcnt vmcnt(22)
    s_barrier
    buffer_load_dwordx4 v[72:75], v2, s[72:75], s66 offen offset:3072
    buffer_load_dwordx4 v[76:79], v2, s[72:75], s67 offen offset:3072
    buffer_load_dwordx4 v[80:83], v3, s[72:75], s64 offen offset:0
    buffer_load_dwordx4 v[84:87], v3, s[72:75], s65 offen offset:0
    buffer_load_dwordx4 v[88:91], v3, s[72:75], s66 offen offset:0
    buffer_load_dwordx4 v[92:95], v3, s[72:75], s67 offen offset:0
    buffer_load_dwordx4 v[96:99], v3, s[72:75], s64 offen offset:1024
    s_waitcnt vmcnt(21)
    s_barrier
    buffer_load_dwordx4 v[100:103], v3, s[72:75], s65 offen offset:1024
    buffer_load_dwordx4 v[104:107], v3, s[72:75], s66 offen offset:1024
    buffer_load_dwordx4 v[108:111], v3, s[72:75], s67 offen offset:1024
    buffer_load_dwordx4 v[112:115], v3, s[72:75], s64 offen offset:2048
    buffer_load_dwordx4 v[116:119], v3, s[72:75], s65 offen offset:2048
    buffer_load_dwordx4 v[120:123], v3, s[72:75], s66 offen offset:2048
    buffer_load_dwordx4 v[124:127], v3, s[72:75], s67 offen offset:2048
    s_branch L_k2p3_24
L_k2nt_38:
    s_waitcnt vmcnt(24)
    s_barrier
    s_waitcnt vmcnt(16)
    s_barrier
    s_waitcnt vmcnt(8)
    s_barrier
    s_waitcnt vmcnt(0)
    s_barrier
    s_barrier
    s_barrier
    s_cmp_lg_u32 s42, 0
    s_cbranch_scc1 L_k3fs_39
    v_mov_b32 v10, 1
    v_lshlrev_b32 v11, 7, v0
    v_add_u32 v11, s97, v11
    s_mov_b64 exec, 16383
    buffer_store_byte v10, v11, s[88:91], 0 offen sc1
    s_mov_b64 exec, -1

L_k3fs_39:
    s_endpgm
L_k2ldB_23:
    s_mov_b32 s49, 5
L_k2pro_40:
    s_add_u32 m0, s46, s44
    s_nop 0

    buffer_load_dwordx4 v4, s[8:11], s47 offen  lds
    buffer_load_dwordx4 v5, s[8:11], s47 offen offset:1024  lds
    buffer_load_dwordx4 v6, s[8:11], s47 offen offset:2048  lds
    buffer_load_dwordx4 v7, s[8:11], s47 offen offset:3072  lds

    s_add_u32 m0, s46, s45
    s_add_u32 s47, s47, 128

    s_bitcmp1_b32 s100, 0
    s_cselect_b32 s47, s101, s51
    s_cselect_b32 s48, 4, 0
    s_cselect_b32 s24, 0, 1
    s_add_u32 s101, s101, s48
    s_add_u32 s51, s51, s24
    s_and_b32 s24, s51, 3
    s_cmp_eq_u32 s24, s50
    s_addc_u32 s51, s51, 0
    s_lshr_b32 s100, s100, 1
    s_mul_i32 s48, s47, 14336
    s_lshl_b32 s47, s47, 7
    s_add_u32 s46, s46, 30720
    s_cmp_eq_u32 s46, 153600
    s_cselect_b32 s46, 0, s46

    s_sub_u32 s49, s49, 1
    s_cmp_lg_u32 s49, 0
    s_cbranch_scc1 L_k2pro_40

    s_load_dwordx2 s[92:93], s[0:1], 88
    s_lshl_b32 s57, s38, 3
    s_add_u32 s57, s57, s37
    s_mul_i32 s96, s36, 2048
    s_lshl_b32 s58, s57, 7
    s_add_u32 s97, s96, s57
    s_add_u32 s96, s96, s58
    s_cmp_ge_u32 s57, 7
    s_cselect_b32 s58, 1, 0
    s_cselect_b32 s59, 7, 0
    s_lshl_b32 s52, s36, 1
    s_add_u32 s52, s52, s58
    s_sub_u32 s53, s57, s59
    s_mul_i32 s55, s42, 7168
    s_lshl_b32 s56, s52, 2
    v_lshlrev_b32 v2, 4, v0
    v_add_u32 v3, 0x1000, v2

    s_add_u32 s58, s42, 0
    s_and_b32 s58, s58, 3
    s_add_u32 s58, s58, s56
    s_mul_i32 s58, s58, 28672
    s_add_u32 s60, s58, s55

    s_add_u32 s58, s42, 1
    s_and_b32 s58, s58, 3
    s_add_u32 s58, s58, s56
    s_mul_i32 s58, s58, 28672
    s_add_u32 s61, s58, s55

    s_add_u32 s58, s42, 2
    s_and_b32 s58, s58, 3
    s_add_u32 s58, s58, s56
    s_mul_i32 s58, s58, 28672
    s_add_u32 s62, s58, s55

    s_add_u32 s58, s42, 3
    s_and_b32 s58, s58, 3
    s_add_u32 s58, s58, s56
    s_mul_i32 s58, s58, 28672
    s_add_u32 s63, s58, s55

    s_mul_i32 s58, s53, 114688
    s_add_u32 s64, s58, s55
    s_add_u32 s65, s64, 28672
    s_add_u32 s66, s65, 28672
    s_add_u32 s67, s66, 28672
    s_add_u32 s68, s32, 12582912
    s_addc_u32 s69, s33, 0
    s_mov_b32 s70, 3670016
    s_mov_b32 s71, 0x20000
    s_add_u32 s72, s32, 20971520
    s_addc_u32 s73, s33, 0
    s_mov_b32 s74, 802816
    s_mov_b32 s75, 0x20000
    s_add_u32 s76, s32, 16777216
    s_addc_u32 s77, s33, 0
    s_mov_b32 s78, 3670016
    s_mov_b32 s79, 0x20000
    s_add_u32 s80, s32, 22020096
    s_addc_u32 s81, s33, 0
    s_mov_b32 s82, 8192
    s_mov_b32 s83, 0x20000
    s_waitcnt lgkmcnt(0)
    s_mov_b32 s84, s92
    s_mov_b32 s85, s93
    s_mov_b32 s86, 1835008
    s_mov_b32 s87, 0x20000
    s_add_u32 s88, s32, 24117248
    s_addc_u32 s89, s33, 0
    s_mov_b32 s90, 32768
    s_mov_b32 s91, 0x20000

    s_mov_b32 s100, s28
    s_mov_b32 s101, s50
    s_cmp_eq_u32 s50, 0
    s_cselect_b32 s51, 1, 0

    s_bitcmp1_b32 s100, 0
    s_cselect_b32 s47, s101, s51
    s_cselect_b32 s48, 4, 0
    s_cselect_b32 s24, 0, 1
    s_add_u32 s101, s101, s48
    s_add_u32 s51, s51, s24
    s_and_b32 s24, s51, 3
    s_cmp_eq_u32 s24, s50
    s_addc_u32 s51, s51, 0
    s_lshr_b32 s100, s100, 1
    s_mul_i32 s48, s47, 14336
    s_lshl_b32 s47, s47, 7
    s_mov_b32 s46, 0
    s_barrier
    s_mov_b32 s49, 5
L_k2pro_41:
    s_add_u32 m0, s46, s44
    s_nop 0

    s_add_u32 m0, s46, s45
    s_add_u32 s47, s47, 128

    buffer_load_dwordx4 v8, s[12:15], s48 offen offset:0  lds
    buffer_load_dwordx4 v8, s[12:15], s48 offen offset:1024  lds
    buffer_load_dwordx4 v8, s[12:15], s48 offen offset:2048  lds
    s_bitcmp1_b32 s100, 0
    s_cselect_b32 s47, s101, s51
    s_cselect_b32 s48, 4, 0
    s_cselect_b32 s24, 0, 1
    s_add_u32 s101, s101, s48
    s_add_u32 s51, s51, s24
    s_and_b32 s24, s51, 3
    s_cmp_eq_u32 s24, s50
    s_addc_u32 s51, s51, 0
    s_lshr_b32 s100, s100, 1
    s_mul_i32 s48, s47, 14336
    s_lshl_b32 s47, s47, 7
    s_add_u32 s46, s46, 30720
    s_cmp_eq_u32 s46, 153600
    s_cselect_b32 s46, 0, s46

    s_sub_u32 s49, s49, 1
    s_cmp_lg_u32 s49, 0
    s_cbranch_scc1 L_k2pro_41

    s_waitcnt vmcnt(12)
    s_barrier
    s_waitcnt vmcnt(9)
    s_barrier
    s_add_u32 m0, s46, s44
    s_nop 0

    buffer_load_dwordx4 v4, s[8:11], s47 offen  lds
    buffer_load_dwordx4 v5, s[8:11], s47 offen offset:1024  lds
    buffer_load_dwordx4 v6, s[8:11], s47 offen offset:2048  lds
    buffer_load_dwordx4 v7, s[8:11], s47 offen offset:3072  lds

    s_add_u32 m0, s46, s45
    s_add_u32 s47, s47, 128

    buffer_load_dwordx4 v8, s[12:15], s48 offen offset:0  lds
    buffer_load_dwordx4 v8, s[12:15], s48 offen offset:1024  lds
    buffer_load_dwordx4 v8, s[12:15], s48 offen offset:2048  lds
    s_bitcmp1_b32 s100, 0
    s_cselect_b32 s47, s101, s51
    s_cselect_b32 s48, 4, 0
    s_cselect_b32 s24, 0, 1
    s_add_u32 s101, s101, s48
    s_add_u32 s51, s51, s24
    s_and_b32 s24, s51, 3
    s_cmp_eq_u32 s24, s50
    s_addc_u32 s51, s51, 0
    s_lshr_b32 s100, s100, 1
    s_mul_i32 s48, s47, 14336
    s_lshl_b32 s47, s47, 7
    s_add_u32 s46, s46, 30720
    s_cmp_eq_u32 s46, 153600
    s_cselect_b32 s46, 0, s46

    s_waitcnt vmcnt(13)
    s_barrier
    s_add_u32 m0, s46, s44
    s_nop 0

    buffer_load_dwordx4 v4, s[8:11], s47 offen  lds
    buffer_load_dwordx4 v5, s[8:11], s47 offen offset:1024  lds
    buffer_load_dwordx4 v6, s[8:11], s47 offen offset:2048  lds
    buffer_load_dwordx4 v7, s[8:11], s47 offen offset:3072  lds

    s_add_u32 m0, s46, s45
    s_add_u32 s47, s47, 128

    buffer_load_dwordx4 v8, s[12:15], s48 offen offset:0  lds
    buffer_load_dwordx4 v8, s[12:15], s48 offen offset:1024  lds
    buffer_load_dwordx4 v8, s[12:15], s48 offen offset:2048  lds
    s_bitcmp1_b32 s100, 0
    s_cselect_b32 s47, s101, s51
    s_cselect_b32 s48, 4, 0
    s_cselect_b32 s24, 0, 1
    s_add_u32 s101, s101, s48
    s_add_u32 s51, s51, s24
    s_and_b32 s24, s51, 3
    s_cmp_eq_u32 s24, s50
    s_addc_u32 s51, s51, 0
    s_lshr_b32 s100, s100, 1
    s_mul_i32 s48, s47, 14336
    s_lshl_b32 s47, s47, 7
    s_add_u32 s46, s46, 30720
    s_cmp_eq_u32 s46, 153600
    s_cselect_b32 s46, 0, s46

    s_waitcnt vmcnt(17)
    s_barrier
    s_add_u32 m0, s46, s44
    s_nop 0

    buffer_load_dwordx4 v4, s[8:11], s47 offen  lds
    buffer_load_dwordx4 v5, s[8:11], s47 offen offset:1024  lds
    buffer_load_dwordx4 v6, s[8:11], s47 offen offset:2048  lds
    buffer_load_dwordx4 v7, s[8:11], s47 offen offset:3072  lds

    s_add_u32 m0, s46, s45
    s_add_u32 s47, s47, 128

    buffer_load_dwordx4 v8, s[12:15], s48 offen offset:0  lds
    buffer_load_dwordx4 v8, s[12:15], s48 offen offset:1024  lds
    buffer_load_dwordx4 v8, s[12:15], s48 offen offset:2048  lds
    s_bitcmp1_b32 s100, 0
    s_cselect_b32 s47, s101, s51
    s_cselect_b32 s48, 4, 0
    s_cselect_b32 s24, 0, 1
    s_add_u32 s101, s101, s48
    s_add_u32 s51, s51, s24
    s_and_b32 s24, s51, 3
    s_cmp_eq_u32 s24, s50
    s_addc_u32 s51, s51, 0
    s_lshr_b32 s100, s100, 1
    s_mul_i32 s48, s47, 14336
    s_lshl_b32 s47, s47, 7
    s_add_u32 s46, s46, 30720
    s_cmp_eq_u32 s46, 153600
    s_cselect_b32 s46, 0, s46

    s_mov_b32 s49, 24
L_k2ldloop_42:
    s_waitcnt vmcnt(21)
    s_barrier
    s_add_u32 m0, s46, s44
    s_nop 0

    buffer_load_dwordx4 v4, s[8:11], s47 offen  lds
    buffer_load_dwordx4 v5, s[8:11], s47 offen offset:1024  lds
    buffer_load_dwordx4 v6, s[8:11], s47 offen offset:2048  lds
    buffer_load_dwordx4 v7, s[8:11], s47 offen offset:3072  lds

    s_add_u32 m0, s46, s45
    s_add_u32 s47, s47, 128

    buffer_load_dwordx4 v8, s[12:15], s48 offen offset:0  lds
    buffer_load_dwordx4 v8, s[12:15], s48 offen offset:1024  lds
    buffer_load_dwordx4 v8, s[12:15], s48 offen offset:2048  lds
    s_bitcmp1_b32 s100, 0
    s_cselect_b32 s47, s101, s51
    s_cselect_b32 s48, 4, 0
    s_cselect_b32 s24, 0, 1
    s_add_u32 s101, s101, s48
    s_add_u32 s51, s51, s24
    s_and_b32 s24, s51, 3
    s_cmp_eq_u32 s24, s50
    s_addc_u32 s51, s51, 0
    s_lshr_b32 s100, s100, 1
    s_mul_i32 s48, s47, 14336
    s_lshl_b32 s47, s47, 7
    s_add_u32 s46, s46, 30720
    s_cmp_eq_u32 s46, 153600
    s_cselect_b32 s46, 0, s46

    s_sub_u32 s49, s49, 1
    s_cmp_lg_u32 s49, 0
    s_cbranch_scc1 L_k2ldloop_42

    s_cmp_ge_u32 s53, 7
    s_cbranch_scc1 L_k2nt_43
    s_waitcnt vmcnt(21)
    s_barrier
    buffer_load_dwordx4 v[16:19], v2, s[72:75], s64 offen offset:0
    buffer_load_dwordx4 v[20:23], v2, s[72:75], s65 offen offset:0
    buffer_load_dwordx4 v[24:27], v2, s[72:75], s66 offen offset:0
    buffer_load_dwordx4 v[28:31], v2, s[72:75], s67 offen offset:0
    buffer_load_dwordx4 v[32:35], v2, s[72:75], s64 offen offset:1024
    buffer_load_dwordx4 v[36:39], v2, s[72:75], s65 offen offset:1024
    buffer_load_dwordx4 v[40:43], v2, s[72:75], s66 offen offset:1024
    s_waitcnt vmcnt(21)
    s_barrier
    buffer_load_dwordx4 v[44:47], v2, s[72:75], s67 offen offset:1024
    buffer_load_dwordx4 v[48:51], v2, s[72:75], s64 offen offset:2048
    buffer_load_dwordx4 v[52:55], v2, s[72:75], s65 offen offset:2048
    buffer_load_dwordx4 v[56:59], v2, s[72:75], s66 offen offset:2048
    buffer_load_dwordx4 v[60:63], v2, s[72:75], s67 offen offset:2048
    buffer_load_dwordx4 v[64:67], v2, s[72:75], s64 offen offset:3072
    buffer_load_dwordx4 v[68:71], v2, s[72:75], s65 offen offset:3072
    s_waitcnt vmcnt(21)
    s_barrier
    buffer_load_dwordx4 v[72:75], v2, s[72:75], s66 offen offset:3072
    buffer_load_dwordx4 v[76:79], v2, s[72:75], s67 offen offset:3072
    buffer_load_dwordx4 v[80:83], v3, s[72:75], s64 offen offset:0
    buffer_load_dwordx4 v[84:87], v3, s[72:75], s65 offen offset:0
    buffer_load_dwordx4 v[88:91], v3, s[72:75], s66 offen offset:0
    buffer_load_dwordx4 v[92:95], v3, s[72:75], s67 offen offset:0
    buffer_load_dwordx4 v[96:99], v3, s[72:75], s64 offen offset:1024
    s_waitcnt vmcnt(21)
    s_barrier
    buffer_load_dwordx4 v[100:103], v3, s[72:75], s65 offen offset:1024
    buffer_load_dwordx4 v[104:107], v3, s[72:75], s66 offen offset:1024
    buffer_load_dwordx4 v[108:111], v3, s[72:75], s67 offen offset:1024
    buffer_load_dwordx4 v[112:115], v3, s[72:75], s64 offen offset:2048
    buffer_load_dwordx4 v[116:119], v3, s[72:75], s65 offen offset:2048
    buffer_load_dwordx4 v[120:123], v3, s[72:75], s66 offen offset:2048
    buffer_load_dwordx4 v[124:127], v3, s[72:75], s67 offen offset:2048
    s_branch L_k2p3_24
L_k2nt_43:
    s_waitcnt vmcnt(21)
    s_barrier
    s_waitcnt vmcnt(14)
    s_barrier
    s_waitcnt vmcnt(7)
    s_barrier
    s_waitcnt vmcnt(0)
    s_barrier
    s_barrier
    s_barrier
    s_cmp_lg_u32 s42, 0
    s_cbranch_scc1 L_k3fs_44
    v_mov_b32 v10, 1
    v_lshlrev_b32 v11, 7, v0
    v_add_u32 v11, s97, v11
    s_mov_b64 exec, 16383
    buffer_store_byte v10, v11, s[88:91], 0 offen sc1
    s_mov_b64 exec, -1

L_k3fs_44:
    s_endpgm
L_k2p3_24:
    s_barrier
    s_barrier
    s_cmp_lg_u32 s42, 0
    s_cbranch_scc1 L_k3fs_45
    v_mov_b32 v10, 1
    v_lshlrev_b32 v11, 7, v0
    v_add_u32 v11, s97, v11
    s_mov_b64 exec, 16383
    buffer_store_byte v10, v11, s[88:91], 0 offen sc1
    s_mov_b64 exec, -1

L_k3fs_45:
    s_add_u32 s58, s56, s42
    s_mul_i32 s98, s58, 28672
    s_lshl_b32 s59, s53, 11
    s_add_u32 s98, s98, s59
    s_add_u32 s99, s98, 14336
    s_lshr_b32 s59, s58, 1
    s_lshl_b32 s59, s59, 5
    s_and_b32 s58, s58, 1
    s_lshl_b32 s58, s58, 2
    s_add_u32 s59, s59, s58
    v_bfe_u32 v4, v0, 2, 2
    v_lshlrev_b32 v4, 3, v4
    v_and_b32 v5, 3, v0
    v_add3_u32 v4, v4, v5, s59
    v_lshlrev_b32 v5, 2, v4
    buffer_load_dword v12, v5, s[80:83], 0 offen
    v_mul_u32_u24 v4, 896, v4
    v_lshrrev_b32 v5, 4, v0
    v_lshl_add_u32 v4, v5, 4, v4
    s_lshl_b32 s59, s53, 7
    v_add_u32 v4, s59, v4

    s_add_u32 s58, s42, 1
    s_and_b32 s58, s58, 3
    s_mul_i32 s58, s58, 12288
    s_add_u32 s58, s58, 0
    v_add_u32 v6, s58, v2

    s_add_u32 s58, s42, 2
    s_and_b32 s58, s58, 3
    s_mul_i32 s58, s58, 12288
    s_add_u32 s58, s58, 4096
    v_add_u32 v7, s58, v2

    s_add_u32 s58, s42, 3
    s_and_b32 s58, s58, 3
    s_mul_i32 s58, s58, 12288
    s_add_u32 s58, s58, 8192
    v_add_u32 v8, s58, v2

    s_mul_i32 s58, s42, 12288
    v_add_u32 v9, s58, v2
    s_cmp_lg_u32 s42, 0
    s_cbranch_scc1 L_k3ok_47
    s_mov_b32 s57, 20000
    v_mov_b32 v10, 0

L_k3poll_46:
    buffer_load_dwordx4 v[192:195], v10, s[88:91], s96 offen sc1
    s_waitcnt vmcnt(0)
    v_and_b32 v192, v192, v193
    v_and_b32 v194, v194, v195
    v_and_b32 v192, v192, v194
    s_nop 0
    v_readfirstlane_b32 s58, v192
    s_cmp_eq_u32 s58, 0x01010101

    s_cbranch_scc1 L_k3ok_47
    s_sleep 2
    s_sub_u32 s57, s57, 1
    s_cmp_lg_u32 s57, 0
    s_cbranch_scc1 L_k3poll_46

L_k3ok_47:
    s_barrier
    s_movk_i32 s57, 400
    buffer_load_dwordx4 v[128:131], v2, s[68:71], s60 offen offset:0 sc1
    buffer_load_dwordx4 v[132:135], v2, s[68:71], s61 offen offset:0 sc1
    buffer_load_dwordx4 v[136:139], v2, s[68:71], s62 offen offset:0 sc1
    buffer_load_dwordx4 v[140:143], v2, s[68:71], s63 offen offset:0 sc1
    buffer_load_dwordx4 v[144:147], v2, s[68:71], s60 offen offset:1024 sc1
    buffer_load_dwordx4 v[148:151], v2, s[68:71], s61 offen offset:1024 sc1
    buffer_load_dwordx4 v[152:155], v2, s[68:71], s62 offen offset:1024 sc1
    buffer_load_dwordx4 v[156:159], v2, s[68:71], s63 offen offset:1024 sc1
    buffer_load_dwordx4 v[160:163], v2, s[68:71], s60 offen offset:2048 sc1
    buffer_load_dwordx4 v[164:167], v2, s[68:71], s61 offen offset:2048 sc1
    buffer_load_dwordx4 v[168:171], v2, s[68:71], s62 offen offset:2048 sc1
    buffer_load_dwordx4 v[172:175], v2, s[68:71], s63 offen offset:2048 sc1
    buffer_load_dwordx4 v[176:179], v2, s[68:71], s60 offen offset:3072 sc1
    buffer_load_dwordx4 v[180:183], v2, s[68:71], s61 offen offset:3072 sc1
    buffer_load_dwordx4 v[184:187], v2, s[68:71], s62 offen offset:3072 sc1
    buffer_load_dwordx4 v[188:191], v2, s[68:71], s63 offen offset:3072 sc1
    s_waitcnt vmcnt(12)
L_k3c_48:
    v_max3_u32 v10, v128, v130, v132
    v_max3_u32 v11, v134, v136, v138
    v_max3_u32 v10, v10, v140, v142
    v_max_u32 v10, v10, v11
    v_cmp_eq_u32 vcc, -1, v10
    s_cbranch_vccnz L_k3r_49

L_k3g_50:
    v_mfma_f32_16x16x32_bf16 v[208:211], v[16:19], v[132:135], 0
    v_mfma_f32_16x16x32_bf16 v[212:215], v[20:23], v[132:135], 0
    v_mfma_f32_16x16x32_bf16 v[216:219], v[24:27], v[132:135], 0
    v_mfma_f32_16x16x32_bf16 v[220:223], v[28:31], v[132:135], 0
    v_mfma_f32_16x16x32_bf16 v[224:227], v[16:19], v[136:139], 0
    v_mfma_f32_16x16x32_bf16 v[228:231], v[20:23], v[136:139], 0
    v_mfma_f32_16x16x32_bf16 v[232:235], v[24:27], v[136:139], 0
    v_mfma_f32_16x16x32_bf16 v[236:239], v[28:31], v[136:139], 0
    v_mfma_f32_16x16x32_bf16 v[240:243], v[16:19], v[140:143], 0
    v_mfma_f32_16x16x32_bf16 v[244:247], v[20:23], v[140:143], 0
    v_mfma_f32_16x16x32_bf16 v[248:251], v[24:27], v[140:143], 0
    v_mfma_f32_16x16x32_bf16 v[252:255], v[28:31], v[140:143], 0
    v_mfma_f32_16x16x32_bf16 v[192:195], v[16:19], v[128:131], 0
    v_mfma_f32_16x16x32_bf16 v[196:199], v[20:23], v[128:131], 0
    v_mfma_f32_16x16x32_bf16 v[200:203], v[24:27], v[128:131], 0
    v_mfma_f32_16x16x32_bf16 v[204:207], v[28:31], v[128:131], 0
    buffer_load_dwordx4 v[16:19], v3, s[68:71], s60 offen offset:0 sc1
    buffer_load_dwordx4 v[20:23], v3, s[68:71], s61 offen offset:0 sc1
    buffer_load_dwordx4 v[24:27], v3, s[68:71], s62 offen offset:0 sc1
    buffer_load_dwordx4 v[28:31], v3, s[68:71], s63 offen offset:0 sc1
    s_waitcnt vmcnt(12)
L_k3c_51:
    v_max3_u32 v10, v144, v146, v148
    v_max3_u32 v11, v150, v152, v154
    v_max3_u32 v10, v10, v156, v158
    v_max_u32 v10, v10, v11
    v_cmp_eq_u32 vcc, -1, v10
    s_cbranch_vccnz L_k3r_52

L_k3g_53:
    v_mfma_f32_16x16x32_bf16 v[208:211], v[32:35], v[148:151], v[208:211]
    v_mfma_f32_16x16x32_bf16 v[212:215], v[36:39], v[148:151], v[212:215]
    v_mfma_f32_16x16x32_bf16 v[216:219], v[40:43], v[148:151], v[216:219]
    v_mfma_f32_16x16x32_bf16 v[220:223], v[44:47], v[148:151], v[220:223]
    v_mfma_f32_16x16x32_bf16 v[224:227], v[32:35], v[152:155], v[224:227]
    v_mfma_f32_16x16x32_bf16 v[228:231], v[36:39], v[152:155], v[228:231]
    v_mfma_f32_16x16x32_bf16 v[232:235], v[40:43], v[152:155], v[232:235]
    v_mfma_f32_16x16x32_bf16 v[236:239], v[44:47], v[152:155], v[236:239]
    v_mfma_f32_16x16x32_bf16 v[240:243], v[32:35], v[156:159], v[240:243]
    v_mfma_f32_16x16x32_bf16 v[244:247], v[36:39], v[156:159], v[244:247]
    v_mfma_f32_16x16x32_bf16 v[248:251], v[40:43], v[156:159], v[248:251]
    v_mfma_f32_16x16x32_bf16 v[252:255], v[44:47], v[156:159], v[252:255]
    v_mfma_f32_16x16x32_bf16 v[192:195], v[32:35], v[144:147], v[192:195]
    v_mfma_f32_16x16x32_bf16 v[196:199], v[36:39], v[144:147], v[196:199]
    v_mfma_f32_16x16x32_bf16 v[200:203], v[40:43], v[144:147], v[200:203]
    v_mfma_f32_16x16x32_bf16 v[204:207], v[44:47], v[144:147], v[204:207]
    buffer_load_dwordx4 v[32:35], v3, s[68:71], s60 offen offset:1024 sc1
    buffer_load_dwordx4 v[36:39], v3, s[68:71], s61 offen offset:1024 sc1
    buffer_load_dwordx4 v[40:43], v3, s[68:71], s62 offen offset:1024 sc1
    buffer_load_dwordx4 v[44:47], v3, s[68:71], s63 offen offset:1024 sc1
    s_waitcnt vmcnt(12)
L_k3c_54:
    v_max3_u32 v10, v160, v162, v164
    v_max3_u32 v11, v166, v168, v170
    v_max3_u32 v10, v10, v172, v174
    v_max_u32 v10, v10, v11
    v_cmp_eq_u32 vcc, -1, v10
    s_cbranch_vccnz L_k3r_55

L_k3g_56:
    v_mfma_f32_16x16x32_bf16 v[208:211], v[48:51], v[164:167], v[208:211]
    v_mfma_f32_16x16x32_bf16 v[212:215], v[52:55], v[164:167], v[212:215]
    v_mfma_f32_16x16x32_bf16 v[216:219], v[56:59], v[164:167], v[216:219]
    v_mfma_f32_16x16x32_bf16 v[220:223], v[60:63], v[164:167], v[220:223]
    v_mfma_f32_16x16x32_bf16 v[224:227], v[48:51], v[168:171], v[224:227]
    v_mfma_f32_16x16x32_bf16 v[228:231], v[52:55], v[168:171], v[228:231]
    v_mfma_f32_16x16x32_bf16 v[232:235], v[56:59], v[168:171], v[232:235]
    v_mfma_f32_16x16x32_bf16 v[236:239], v[60:63], v[168:171], v[236:239]
    v_mfma_f32_16x16x32_bf16 v[240:243], v[48:51], v[172:175], v[240:243]
    v_mfma_f32_16x16x32_bf16 v[244:247], v[52:55], v[172:175], v[244:247]
    v_mfma_f32_16x16x32_bf16 v[248:251], v[56:59], v[172:175], v[248:251]
    v_mfma_f32_16x16x32_bf16 v[252:255], v[60:63], v[172:175], v[252:255]
    v_mfma_f32_16x16x32_bf16 v[192:195], v[48:51], v[160:163], v[192:195]
    v_mfma_f32_16x16x32_bf16 v[196:199], v[52:55], v[160:163], v[196:199]
    v_mfma_f32_16x16x32_bf16 v[200:203], v[56:59], v[160:163], v[200:203]
    v_mfma_f32_16x16x32_bf16 v[204:207], v[60:63], v[160:163], v[204:207]
    buffer_load_dwordx4 v[48:51], v3, s[68:71], s60 offen offset:2048 sc1
    buffer_load_dwordx4 v[52:55], v3, s[68:71], s61 offen offset:2048 sc1
    buffer_load_dwordx4 v[56:59], v3, s[68:71], s62 offen offset:2048 sc1
    buffer_load_dwordx4 v[60:63], v3, s[68:71], s63 offen offset:2048 sc1
    s_waitcnt vmcnt(12)
L_k3c_57:
    v_max3_u32 v10, v176, v178, v180
    v_max3_u32 v11, v182, v184, v186
    v_max3_u32 v10, v10, v188, v190
    v_max_u32 v10, v10, v11
    v_cmp_eq_u32 vcc, -1, v10
    s_cbranch_vccnz L_k3r_58

L_k3g_59:
    v_mfma_f32_16x16x32_bf16 v[208:211], v[64:67], v[180:183], v[208:211]
    v_mfma_f32_16x16x32_bf16 v[212:215], v[68:71], v[180:183], v[212:215]
    v_mfma_f32_16x16x32_bf16 v[216:219], v[72:75], v[180:183], v[216:219]
    v_mfma_f32_16x16x32_bf16 v[220:223], v[76:79], v[180:183], v[220:223]
    v_mfma_f32_16x16x32_bf16 v[224:227], v[64:67], v[184:187], v[224:227]
    v_mfma_f32_16x16x32_bf16 v[228:231], v[68:71], v[184:187], v[228:231]
    v_mfma_f32_16x16x32_bf16 v[232:235], v[72:75], v[184:187], v[232:235]
    v_mfma_f32_16x16x32_bf16 v[236:239], v[76:79], v[184:187], v[236:239]
    v_mfma_f32_16x16x32_bf16 v[240:243], v[64:67], v[188:191], v[240:243]
    v_mfma_f32_16x16x32_bf16 v[244:247], v[68:71], v[188:191], v[244:247]
    v_mfma_f32_16x16x32_bf16 v[248:251], v[72:75], v[188:191], v[248:251]
    v_mfma_f32_16x16x32_bf16 v[252:255], v[76:79], v[188:191], v[252:255]
    v_mfma_f32_16x16x32_bf16 v[192:195], v[64:67], v[176:179], v[192:195]
    v_mfma_f32_16x16x32_bf16 v[196:199], v[68:71], v[176:179], v[196:199]
    v_mfma_f32_16x16x32_bf16 v[200:203], v[72:75], v[176:179], v[200:203]
    v_mfma_f32_16x16x32_bf16 v[204:207], v[76:79], v[176:179], v[204:207]
    buffer_load_dwordx4 v[64:67], v2, s[76:79], s98 offen offset:0 sc1
    buffer_load_dwordx4 v[68:71], v2, s[76:79], s98 offen offset:1024 sc1
    buffer_load_dwordx4 v[72:75], v2, s[76:79], s99 offen offset:0 sc1
    buffer_load_dwordx4 v[76:79], v2, s[76:79], s99 offen offset:1024 sc1
    s_waitcnt vmcnt(12)
L_k3c_60:
    v_max3_u32 v10, v16, v18, v20
    v_max3_u32 v11, v22, v24, v26
    v_max3_u32 v10, v10, v28, v30
    v_max_u32 v10, v10, v11
    v_cmp_eq_u32 vcc, -1, v10
    s_cbranch_vccnz L_k3r_61

L_k3g_62:
    v_mfma_f32_16x16x32_bf16 v[208:211], v[80:83], v[20:23], v[208:211]
    v_mfma_f32_16x16x32_bf16 v[212:215], v[84:87], v[20:23], v[212:215]
    v_mfma_f32_16x16x32_bf16 v[216:219], v[88:91], v[20:23], v[216:219]
    v_mfma_f32_16x16x32_bf16 v[220:223], v[92:95], v[20:23], v[220:223]
    v_mfma_f32_16x16x32_bf16 v[224:227], v[80:83], v[24:27], v[224:227]
    v_mfma_f32_16x16x32_bf16 v[228:231], v[84:87], v[24:27], v[228:231]
    v_mfma_f32_16x16x32_bf16 v[232:235], v[88:91], v[24:27], v[232:235]
    v_mfma_f32_16x16x32_bf16 v[236:239], v[92:95], v[24:27], v[236:239]
    v_mfma_f32_16x16x32_bf16 v[240:243], v[80:83], v[28:31], v[240:243]
    v_mfma_f32_16x16x32_bf16 v[244:247], v[84:87], v[28:31], v[244:247]
    v_mfma_f32_16x16x32_bf16 v[248:251], v[88:91], v[28:31], v[248:251]
    v_mfma_f32_16x16x32_bf16 v[252:255], v[92:95], v[28:31], v[252:255]
    v_mfma_f32_16x16x32_bf16 v[192:195], v[80:83], v[16:19], v[192:195]
    v_mfma_f32_16x16x32_bf16 v[196:199], v[84:87], v[16:19], v[196:199]
    v_mfma_f32_16x16x32_bf16 v[200:203], v[88:91], v[16:19], v[200:203]
    v_mfma_f32_16x16x32_bf16 v[204:207], v[92:95], v[16:19], v[204:207]
    s_waitcnt vmcnt(8)
L_k3c_63:
    v_max3_u32 v10, v32, v34, v36
    v_max3_u32 v11, v38, v40, v42
    v_max3_u32 v10, v10, v44, v46
    v_max_u32 v10, v10, v11
    v_cmp_eq_u32 vcc, -1, v10
    s_cbranch_vccnz L_k3r_64

L_k3g_65:
    v_mfma_f32_16x16x32_bf16 v[208:211], v[96:99], v[36:39], v[208:211]
    v_mfma_f32_16x16x32_bf16 v[212:215], v[100:103], v[36:39], v[212:215]
    v_mfma_f32_16x16x32_bf16 v[216:219], v[104:107], v[36:39], v[216:219]
    v_mfma_f32_16x16x32_bf16 v[220:223], v[108:111], v[36:39], v[220:223]
    v_mfma_f32_16x16x32_bf16 v[224:227], v[96:99], v[40:43], v[224:227]
    v_mfma_f32_16x16x32_bf16 v[228:231], v[100:103], v[40:43], v[228:231]
    v_mfma_f32_16x16x32_bf16 v[232:235], v[104:107], v[40:43], v[232:235]
    v_mfma_f32_16x16x32_bf16 v[236:239], v[108:111], v[40:43], v[236:239]
    v_mfma_f32_16x16x32_bf16 v[240:243], v[96:99], v[44:47], v[240:243]
    v_mfma_f32_16x16x32_bf16 v[244:247], v[100:103], v[44:47], v[244:247]
    v_mfma_f32_16x16x32_bf16 v[248:251], v[104:107], v[44:47], v[248:251]
    v_mfma_f32_16x16x32_bf16 v[252:255], v[108:111], v[44:47], v[252:255]
    v_mfma_f32_16x16x32_bf16 v[192:195], v[96:99], v[32:35], v[192:195]
    v_mfma_f32_16x16x32_bf16 v[196:199], v[100:103], v[32:35], v[196:199]
    v_mfma_f32_16x16x32_bf16 v[200:203], v[104:107], v[32:35], v[200:203]
    v_mfma_f32_16x16x32_bf16 v[204:207], v[108:111], v[32:35], v[204:207]
    s_waitcnt vmcnt(4)
L_k3c_66:
    v_max3_u32 v10, v48, v50, v52
    v_max3_u32 v11, v54, v56, v58
    v_max3_u32 v10, v10, v60, v62
    v_max_u32 v10, v10, v11
    v_cmp_eq_u32 vcc, -1, v10
    s_cbranch_vccnz L_k3r_67

L_k3g_68:
    v_mfma_f32_16x16x32_bf16 v[208:211], v[112:115], v[52:55], v[208:211]
    v_mfma_f32_16x16x32_bf16 v[212:215], v[116:119], v[52:55], v[212:215]
    v_mfma_f32_16x16x32_bf16 v[216:219], v[120:123], v[52:55], v[216:219]
    v_mfma_f32_16x16x32_bf16 v[220:223], v[124:127], v[52:55], v[220:223]
    v_mfma_f32_16x16x32_bf16 v[224:227], v[112:115], v[56:59], v[224:227]
    v_mfma_f32_16x16x32_bf16 v[228:231], v[116:119], v[56:59], v[228:231]
    v_mfma_f32_16x16x32_bf16 v[232:235], v[120:123], v[56:59], v[232:235]
    v_mfma_f32_16x16x32_bf16 v[236:239], v[124:127], v[56:59], v[236:239]
    v_mfma_f32_16x16x32_bf16 v[240:243], v[112:115], v[60:63], v[240:243]
    v_mfma_f32_16x16x32_bf16 v[244:247], v[116:119], v[60:63], v[244:247]
    v_mfma_f32_16x16x32_bf16 v[248:251], v[120:123], v[60:63], v[248:251]
    v_mfma_f32_16x16x32_bf16 v[252:255], v[124:127], v[60:63], v[252:255]
    v_mfma_f32_16x16x32_bf16 v[192:195], v[112:115], v[48:51], v[192:195]
    v_mfma_f32_16x16x32_bf16 v[196:199], v[116:119], v[48:51], v[196:199]
    v_mfma_f32_16x16x32_bf16 v[200:203], v[120:123], v[48:51], v[200:203]
    v_mfma_f32_16x16x32_bf16 v[204:207], v[124:127], v[48:51], v[204:207]
    ds_write_b128 v6, v[208:211] offset:0
    ds_write_b128 v6, v[212:215] offset:1024
    ds_write_b128 v6, v[216:219] offset:2048
    ds_write_b128 v6, v[220:223] offset:3072
    ds_write_b128 v7, v[224:227] offset:0
    ds_write_b128 v7, v[228:231] offset:1024
    ds_write_b128 v7, v[232:235] offset:2048
    ds_write_b128 v7, v[236:239] offset:3072
    ds_write_b128 v8, v[240:243] offset:0
    ds_write_b128 v8, v[244:247] offset:1024
    ds_write_b128 v8, v[248:251] offset:2048
    ds_write_b128 v8, v[252:255] offset:3072
    s_waitcnt vmcnt(0)
    v_sub_f32 v13, 1.0, v12

    v_lshlrev_b32 v96, 16, v64
    v_lshlrev_b32 v10, 16, v72
    v_and_b32 v97, 0xffff0000, v64
    v_and_b32 v11, 0xffff0000, v72
    v_sub_f32 v96, v96, v10
    v_sub_f32 v97, v97, v11
    v_mul_f32 v96, v96, v12
    v_mul_f32 v97, v97, v12

    v_lshlrev_b32 v98, 16, v65
    v_lshlrev_b32 v10, 16, v73
    v_and_b32 v99, 0xffff0000, v65
    v_and_b32 v11, 0xffff0000, v73
    v_sub_f32 v98, v98, v10
    v_sub_f32 v99, v99, v11
    v_mul_f32 v98, v98, v12
    v_mul_f32 v99, v99, v12

    v_lshlrev_b32 v100, 16, v66
    v_lshlrev_b32 v10, 16, v74
    v_and_b32 v101, 0xffff0000, v66
    v_and_b32 v11, 0xffff0000, v74
    v_sub_f32 v100, v100, v10
    v_sub_f32 v101, v101, v11
    v_mul_f32 v100, v100, v12
    v_mul_f32 v101, v101, v12

    v_lshlrev_b32 v102, 16, v67
    v_lshlrev_b32 v10, 16, v75
    v_and_b32 v103, 0xffff0000, v67
    v_and_b32 v11, 0xffff0000, v75
    v_sub_f32 v102, v102, v10
    v_sub_f32 v103, v103, v11
    v_mul_f32 v102, v102, v12
    v_mul_f32 v103, v103, v12

    v_lshlrev_b32 v104, 16, v68
    v_lshlrev_b32 v10, 16, v76
    v_and_b32 v105, 0xffff0000, v68
    v_and_b32 v11, 0xffff0000, v76
    v_sub_f32 v104, v104, v10
    v_sub_f32 v105, v105, v11
    v_mul_f32 v104, v104, v12
    v_mul_f32 v105, v105, v12

    v_lshlrev_b32 v106, 16, v69
    v_lshlrev_b32 v10, 16, v77
    v_and_b32 v107, 0xffff0000, v69
    v_and_b32 v11, 0xffff0000, v77
    v_sub_f32 v106, v106, v10
    v_sub_f32 v107, v107, v11
    v_mul_f32 v106, v106, v12
    v_mul_f32 v107, v107, v12

    v_lshlrev_b32 v108, 16, v70
    v_lshlrev_b32 v10, 16, v78
    v_and_b32 v109, 0xffff0000, v70
    v_and_b32 v11, 0xffff0000, v78
    v_sub_f32 v108, v108, v10
    v_sub_f32 v109, v109, v11
    v_mul_f32 v108, v108, v12
    v_mul_f32 v109, v109, v12

    v_lshlrev_b32 v110, 16, v71
    v_lshlrev_b32 v10, 16, v79
    v_and_b32 v111, 0xffff0000, v71
    v_and_b32 v11, 0xffff0000, v79
    v_sub_f32 v110, v110, v10
    v_sub_f32 v111, v111, v11
    v_mul_f32 v110, v110, v12
    v_mul_f32 v111, v111, v12

    s_waitcnt lgkmcnt(0)
    s_barrier
    ds_read_b128 v[128:131], v9 offset:0
    ds_read_b128 v[132:135], v9 offset:4096
    ds_read_b128 v[136:139], v9 offset:8192
    ds_read_b128 v[140:143], v9 offset:1024
    ds_read_b128 v[144:147], v9 offset:5120
    ds_read_b128 v[148:151], v9 offset:9216
    ds_read_b128 v[152:155], v9 offset:2048
    ds_read_b128 v[156:159], v9 offset:6144
    ds_read_b128 v[160:163], v9 offset:10240
    ds_read_b128 v[164:167], v9 offset:3072
    ds_read_b128 v[168:171], v9 offset:7168
    ds_read_b128 v[172:175], v9 offset:11264
    s_waitcnt lgkmcnt(9)
    v_add_f32 v192, v192, v128
    v_add_f32 v132, v132, v136
    v_add_f32 v193, v193, v129
    v_add_f32 v133, v133, v137
    v_add_f32 v194, v194, v130
    v_add_f32 v134, v134, v138
    v_add_f32 v195, v195, v131
    v_add_f32 v135, v135, v139
    v_add_f32 v192, v192, v132
    v_add_f32 v193, v193, v133
    v_add_f32 v194, v194, v134
    v_add_f32 v195, v195, v135
    v_fma_f32 v192, v192, v13, v96
    v_fma_f32 v193, v193, v13, v97
    v_fma_f32 v194, v194, v13, v98
    v_fma_f32 v195, v195, v13, v99
    v_cvt_pk_bf16_f32 v80, v192, v193
    v_cvt_pk_bf16_f32 v81, v194, v195
    s_waitcnt lgkmcnt(6)
    v_add_f32 v196, v196, v140
    v_add_f32 v144, v144, v148
    v_add_f32 v197, v197, v141
    v_add_f32 v145, v145, v149
    v_add_f32 v198, v198, v142
    v_add_f32 v146, v146, v150
    v_add_f32 v199, v199, v143
    v_add_f32 v147, v147, v151
    v_add_f32 v196, v196, v144
    v_add_f32 v197, v197, v145
    v_add_f32 v198, v198, v146
    v_add_f32 v199, v199, v147
    v_fma_f32 v196, v196, v13, v100
    v_fma_f32 v197, v197, v13, v101
    v_fma_f32 v198, v198, v13, v102
    v_fma_f32 v199, v199, v13, v103
    v_cvt_pk_bf16_f32 v82, v196, v197
    v_cvt_pk_bf16_f32 v83, v198, v199
    buffer_store_dwordx4 v[80:83], v4, s[84:87], 0 offen offset:0 sc1
    s_waitcnt lgkmcnt(3)
    v_add_f32 v200, v200, v152
    v_add_f32 v156, v156, v160
    v_add_f32 v201, v201, v153
    v_add_f32 v157, v157, v161
    v_add_f32 v202, v202, v154
    v_add_f32 v158, v158, v162
    v_add_f32 v203, v203, v155
    v_add_f32 v159, v159, v163
    v_add_f32 v200, v200, v156
    v_add_f32 v201, v201, v157
    v_add_f32 v202, v202, v158
    v_add_f32 v203, v203, v159
    v_fma_f32 v200, v200, v13, v104
    v_fma_f32 v201, v201, v13, v105
    v_fma_f32 v202, v202, v13, v106
    v_fma_f32 v203, v203, v13, v107
    v_cvt_pk_bf16_f32 v84, v200, v201
    v_cvt_pk_bf16_f32 v85, v202, v203
    s_waitcnt lgkmcnt(0)
    v_add_f32 v204, v204, v164
    v_add_f32 v168, v168, v172
    v_add_f32 v205, v205, v165
    v_add_f32 v169, v169, v173
    v_add_f32 v206, v206, v166
    v_add_f32 v170, v170, v174
    v_add_f32 v207, v207, v167
    v_add_f32 v171, v171, v175
    v_add_f32 v204, v204, v168
    v_add_f32 v205, v205, v169
    v_add_f32 v206, v206, v170
    v_add_f32 v207, v207, v171
    v_fma_f32 v204, v204, v13, v108
    v_fma_f32 v205, v205, v13, v109
    v_fma_f32 v206, v206, v13, v110
    v_fma_f32 v207, v207, v13, v111
    v_cvt_pk_bf16_f32 v86, v204, v205
    v_cvt_pk_bf16_f32 v87, v206, v207
    buffer_store_dwordx4 v[84:87], v4, s[84:87], 0 offen offset:64 sc1
    s_endpgm
L_k3r_49:
    s_sub_u32 s57, s57, 1
    s_cmp_lt_i32 s57, 0
    s_cbranch_scc1 L_k3g_50
    buffer_load_dwordx4 v[128:131], v2, s[68:71], s60 offen offset:0 sc1
    buffer_load_dwordx4 v[132:135], v2, s[68:71], s61 offen offset:0 sc1
    buffer_load_dwordx4 v[136:139], v2, s[68:71], s62 offen offset:0 sc1
    buffer_load_dwordx4 v[140:143], v2, s[68:71], s63 offen offset:0 sc1
    s_waitcnt vmcnt(0)
    s_branch L_k3c_48
L_k3r_52:
    s_sub_u32 s57, s57, 1
    s_cmp_lt_i32 s57, 0
    s_cbranch_scc1 L_k3g_53
    buffer_load_dwordx4 v[144:147], v2, s[68:71], s60 offen offset:1024 sc1
    buffer_load_dwordx4 v[148:151], v2, s[68:71], s61 offen offset:1024 sc1
    buffer_load_dwordx4 v[152:155], v2, s[68:71], s62 offen offset:1024 sc1
    buffer_load_dwordx4 v[156:159], v2, s[68:71], s63 offen offset:1024 sc1
    s_waitcnt vmcnt(0)
    s_branch L_k3c_51
L_k3r_55:
    s_sub_u32 s57, s57, 1
    s_cmp_lt_i32 s57, 0
    s_cbranch_scc1 L_k3g_56
    buffer_load_dwordx4 v[160:163], v2, s[68:71], s60 offen offset:2048 sc1
    buffer_load_dwordx4 v[164:167], v2, s[68:71], s61 offen offset:2048 sc1
    buffer_load_dwordx4 v[168:171], v2, s[68:71], s62 offen offset:2048 sc1
    buffer_load_dwordx4 v[172:175], v2, s[68:71], s63 offen offset:2048 sc1
    s_waitcnt vmcnt(0)
    s_branch L_k3c_54
L_k3r_58:
    s_sub_u32 s57, s57, 1
    s_cmp_lt_i32 s57, 0
    s_cbranch_scc1 L_k3g_59
    buffer_load_dwordx4 v[176:179], v2, s[68:71], s60 offen offset:3072 sc1
    buffer_load_dwordx4 v[180:183], v2, s[68:71], s61 offen offset:3072 sc1
    buffer_load_dwordx4 v[184:187], v2, s[68:71], s62 offen offset:3072 sc1
    buffer_load_dwordx4 v[188:191], v2, s[68:71], s63 offen offset:3072 sc1
    s_waitcnt vmcnt(0)
    s_branch L_k3c_57
L_k3r_61:
    s_sub_u32 s57, s57, 1
    s_cmp_lt_i32 s57, 0
    s_cbranch_scc1 L_k3g_62
    buffer_load_dwordx4 v[16:19], v3, s[68:71], s60 offen offset:0 sc1
    buffer_load_dwordx4 v[20:23], v3, s[68:71], s61 offen offset:0 sc1
    buffer_load_dwordx4 v[24:27], v3, s[68:71], s62 offen offset:0 sc1
    buffer_load_dwordx4 v[28:31], v3, s[68:71], s63 offen offset:0 sc1
    s_waitcnt vmcnt(0)
    s_branch L_k3c_60
L_k3r_64:
    s_sub_u32 s57, s57, 1
    s_cmp_lt_i32 s57, 0
    s_cbranch_scc1 L_k3g_65
    buffer_load_dwordx4 v[32:35], v3, s[68:71], s60 offen offset:1024 sc1
    buffer_load_dwordx4 v[36:39], v3, s[68:71], s61 offen offset:1024 sc1
    buffer_load_dwordx4 v[40:43], v3, s[68:71], s62 offen offset:1024 sc1
    buffer_load_dwordx4 v[44:47], v3, s[68:71], s63 offen offset:1024 sc1
    s_waitcnt vmcnt(0)
    s_branch L_k3c_63
L_k3r_67:
    s_sub_u32 s57, s57, 1
    s_cmp_lt_i32 s57, 0
    s_cbranch_scc1 L_k3g_68
    buffer_load_dwordx4 v[48:51], v3, s[68:71], s60 offen offset:2048 sc1
    buffer_load_dwordx4 v[52:55], v3, s[68:71], s61 offen offset:2048 sc1
    buffer_load_dwordx4 v[56:59], v3, s[68:71], s62 offen offset:2048 sc1
    buffer_load_dwordx4 v[60:63], v3, s[68:71], s63 offen offset:2048 sc1
    s_waitcnt vmcnt(0)
    s_branch L_k3c_66
L_k2end_17:
    s_endpgm
L_code_end:
.section .rodata,"a"
.p2align 6
.amdhsa_kernel k1_kernel
  .amdhsa_next_free_vgpr 256
  .amdhsa_next_free_sgpr 102
  .amdhsa_accum_offset 256
  .amdhsa_group_segment_fixed_size 0
  .amdhsa_kernarg_size 112
  .amdhsa_user_sgpr_count 2
  .amdhsa_user_sgpr_kernarg_segment_ptr 1
  .amdhsa_system_sgpr_workgroup_id_x 1
.end_amdhsa_kernel
```
